```python
import torch

def _softmax(x, axis=-1):
    return torch.softmax(x, dim=axis)
def _gelu(x):
    return torch.nn.functional.gelu(x, approximate="tanh")
def _silu(x):
    return torch.nn.functional.silu(x)
def _sigmoid(x):
    return torch.sigmoid(x)
def _layernorm(x, axis=-1, eps=1e-5):
    m = x.mean(dim=axis, keepdim=True)
    v = x.var(dim=axis, keepdim=True, unbiased=False)
    return (x - m) / torch.sqrt(v + eps)
def _scatter_add(tgt, idx, src, axis=0):
    return tgt.clone().index_add_(axis, idx, src)
def _segment_sum(src, seg, n):
    out = torch.zeros((n,) + src.shape[1:], dtype=src.dtype)
    return out.index_add_(0, seg, src)
def _pad(x, pw):
    flat = tuple(v for pair in reversed(pw) for v in pair)
    return torch.nn.functional.pad(x, flat)

kernel_name = 'parallel_sum__gqa_block_cached__geglu_ffn__decode'

def setup_inputs():

    _w = (lambda a: (lambda t: t.to(torch.bfloat16) if t.is_floating_point() else t)(torch.as_tensor(a)))
    def _A_setup():
        B, Sq, D = 2, 1, 1024
        Hq, Hkv, Sk, Dh = 32, 4, 32768, 128
        assert Hq % Hkv == 0, (Hq, Hkv)
        return {
            "x": _w((lambda *s: torch.randn(*s, dtype=torch.bfloat16) * 0.05)(B, Sq, D)),
            "k_cache": _w((lambda *s: torch.randn(*s, dtype=torch.bfloat16) * 3.2)(B, Hkv, Sk, Dh)),
            "v_cache": _w((lambda *s: torch.randn(*s, dtype=torch.bfloat16) * 1.6)(B, Hkv, Sk, Dh)),
            "wq": _w((lambda *s: torch.randn(*s, dtype=torch.bfloat16) * 3.2)(D, Hq * Dh) * (D ** -0.5)),
            "wo": _w((lambda *s: torch.randn(*s, dtype=torch.bfloat16) * 1.6)(Hq * Dh, D) * ((Hq * Dh) ** -0.5)),
        }
    _A_in = _A_setup()

    def _B_setup():
        B, S, D, F = 2, 1, 1024, 3584
        return {
            "x": _w((lambda *s: torch.randn(*s, dtype=torch.bfloat16) * 0.05)(B, S, D)),
            "w_gate": _w((lambda *s: torch.randn(*s, dtype=torch.bfloat16) * 0.05)(D, F)),
            "w_up": _w((lambda *s: torch.randn(*s, dtype=torch.bfloat16) * 0.05)(D, F)),
            "w_down": _w((lambda *s: torch.randn(*s, dtype=torch.bfloat16) * 0.05)(F, D)),
        }
    _B_in = _B_setup()

    return {
        "A_x": _A_in["x"],
        "A_k_cache": _A_in["k_cache"],
        "A_v_cache": _A_in["v_cache"],
        "A_wq": _A_in["wq"],
        "A_wo": _A_in["wo"],
        "B_x": _B_in["x"],
        "B_w_gate": _B_in["w_gate"],
        "B_w_up": _B_in["w_up"],
        "B_w_down": _B_in["w_down"],
    }

def reference(A_x, A_k_cache, A_v_cache, A_wq, A_wo, B_x, B_w_gate, B_w_up, B_w_down):
    def _A_ref(x, k_cache, v_cache, wq, wo):
        B, Sq, D = x.shape
        Hq, Dh = 32, 128
        Hkv = k_cache.shape[1]
        rep = Hq // Hkv
        q = (lambda x, *d: x.permute(*d))((x @ wq).reshape(B, Sq, Hq, Dh), 0, 2, 1, 3)
        k = (lambda x, n, axis: torch.repeat_interleave(x, n, dim=axis))(k_cache, rep, axis=1)
        v = (lambda x, n, axis: torch.repeat_interleave(x, n, dim=axis))(v_cache, rep, axis=1)
        scores = torch.einsum("bhqd,bhkd->bhqk", q, k) * (Dh ** -0.5)
        p = _softmax(scores, axis=-1)
        o = torch.einsum("bhqk,bhkd->bhqd", p, v)
        return (lambda x, *d: x.permute(*d))(o, 0, 2, 1, 3).reshape(B, Sq, Hq * Dh) @ wo

    def _B_ref(x, w_gate, w_up, w_down):
        return (_gelu(x @ w_gate) * (x @ w_up)) @ w_down

    x = A_x
    xn = _layernorm(x, axis=-1)
    return x + _A_ref(xn, A_k_cache, A_v_cache, A_wq, A_wo) + _B_ref(xn, B_w_gate, B_w_up, B_w_down)
```

```asm
; @launch grid=(256,1,1) block=(512,1,1) lds=21760
.amdgcn_target "amdgcn-amd-amdhsa--gfx950"
.text
.globl parallel_sum__gqa_block_cached__geglu_ffn__decode_kernel
.p2align 8
.type parallel_sum__gqa_block_cached__geglu_ffn__decode_kernel,@function
parallel_sum__gqa_block_cached__geglu_ffn__decode_kernel:
    s_cmp_ge_u32 s2, 256
    s_cbranch_scc1 L_END
    s_load_dwordx16 s[16:31], s[0:1], 0
    s_load_dwordx8 s[32:39], s[0:1], 64
    v_lshrrev_b32 v3, 6, v0
    s_and_b32 s96, s2, 7
    s_lshr_b32 s97, s2, 3
    v_and_b32 v0, 63, v0
    v_readfirstlane_b32 s3, v3
    s_lshl_b32 s99, s96, 5
    s_or_b32 s99, s99, s97
    s_lshr_b32 s98, s2, 5
    v_and_b32 v4, 15, v0
    v_lshrrev_b32 v5, 4, v0
    v_mov_b32 v14, 0
    v_lshrrev_b32 v8, 3, v4
    v_and_b32 v9, 7, v4
    s_cmp_lt_u32 s3, 4
    s_cbranch_scc1 L_SVC
    s_sub_u32 s6, s3, 4
    v_bfe_u32 v6, v4, 1, 1
    v_lshrrev_b32 v7, 2, v4
    v_lshl_add_u32 v6, v6, 2, v7
    v_lshlrev_b32 v6, 8, v6
    v_lshl_add_u32 v6, v5, 5, v6
    v_and_b32 v7, 1, v4
    v_lshl_add_u32 v6, v7, 4, v6
    s_lshl_b32 s7, s99, 18
    s_lshl_b32 s8, s6, 12
    s_add_u32 s7, s7, s8
    s_mov_b32 s8, s7
    s_waitcnt lgkmcnt(0)
    s_mov_b32 s40, s18
    s_mov_b32 s41, s19
    s_mov_b32 s42, 0x4000000
    s_mov_b32 s43, 0x20000
    buffer_load_dwordx4 v[16:19], v6, s[40:43], s7 offen offset:0 nt
    buffer_load_dwordx4 v[20:23], v6, s[40:43], s7 offen offset:128 nt
    s_branch L_ATT2
L_SVC:
    s_and_b32 s7, s97, 3
    v_lshlrev_b32 v10, 3, v8
    v_lshl_add_u32 v10, v5, 4, v10
    s_cmp_lg_u32 s3, 0
    s_cbranch_scc1 L_S123
    s_lshl3_add_u32 s6, s98, s96
    s_mul_i32 s4, s6, 37
    s_lshr_b32 s4, s4, 8
    s_mul_i32 s5, s4, 7
    s_sub_u32 s5, s6, s5
    s_cmp_ge_u32 s5, 3
    s_addc_u32 s5, s5, 0
    s_lshl_b32 s4, s4, 3
    s_add_u32 s5, s5, s4
    s_lshl_b32 s4, s6, 3
    s_sub_u32 s4, s4, 445
    s_cmp_ge_u32 s6, 56
    s_cselect_b32 s6, s4, s5
    v_lshlrev_b32 v6, 6, v0
    v_lshrrev_b32 v7, 5, v0
    v_lshlrev_b32 v7, 11, v7
    v_and_b32 v11, 31, v0
    v_lshl_add_u32 v7, v11, 4, v7
    s_lshl_b32 s12, s7, 9
    v_lshlrev_b32 v10, 13, v10
    v_lshl_add_u32 v10, v9, 4, v10
    s_lshl_b32 s10, s7, 21
    s_lshl_b32 s11, s6, 7
    s_add_u32 s10, s10, s11
    s_waitcnt lgkmcnt(0)
    s_mov_b32 s56, s16
    s_mov_b32 s57, s17
    s_mov_b32 s58, 0x1000
    s_mov_b32 s59, 0x20000
    s_mov_b32 s40, s22
    s_mov_b32 s41, s23
    s_mov_b32 s42, 0x800000
    s_mov_b32 s43, 0x20000
    s_load_dword s14, s[38:39], 0x70000
    buffer_load_dwordx4 v[16:19], v6, s[56:59], 0 offen offset:0
    buffer_load_dwordx4 v[20:23], v6, s[56:59], 0 offen offset:16
    buffer_load_dwordx4 v[24:27], v6, s[56:59], 0 offen offset:32
    buffer_load_dwordx4 v[28:31], v6, s[56:59], 0 offen offset:48
    buffer_load_dwordx4 v[32:35], v7, s[56:59], s12 offen
    buffer_load_dwordx4 v[72:75], v10, s[40:43], s10 offen nt
    s_add_u32 s10, s10, 8192
    buffer_load_dwordx4 v[76:79], v10, s[40:43], s10 offen nt
    s_add_u32 s10, s10, 8192
    buffer_load_dwordx4 v[80:83], v10, s[40:43], s10 offen nt
    s_add_u32 s10, s10, 8192
    buffer_load_dwordx4 v[84:87], v10, s[40:43], s10 offen nt
    s_add_u32 s10, s10, 8192
    buffer_load_dwordx4 v[88:91], v10, s[40:43], s10 offen nt
    s_add_u32 s10, s10, 8192
    buffer_load_dwordx4 v[92:95], v10, s[40:43], s10 offen nt
    s_add_u32 s10, s10, 8192
    buffer_load_dwordx4 v[96:99], v10, s[40:43], s10 offen nt
    s_add_u32 s10, s10, 8192
    buffer_load_dwordx4 v[100:103], v10, s[40:43], s10 offen nt
    s_add_u32 s10, s10, 466944
    buffer_load_dwordx4 v[104:107], v10, s[40:43], s10 offen nt
    s_add_u32 s10, s10, 8192
    buffer_load_dwordx4 v[108:111], v10, s[40:43], s10 offen nt
    s_add_u32 s10, s10, 8192
    buffer_load_dwordx4 v[112:115], v10, s[40:43], s10 offen nt
    s_add_u32 s10, s10, 8192
    buffer_load_dwordx4 v[116:119], v10, s[40:43], s10 offen nt
    s_add_u32 s10, s10, 8192
    buffer_load_dwordx4 v[120:123], v10, s[40:43], s10 offen nt
    s_add_u32 s10, s10, 8192
    buffer_load_dwordx4 v[124:127], v10, s[40:43], s10 offen nt
    s_add_u32 s10, s10, 8192
    buffer_load_dwordx4 v[128:131], v10, s[40:43], s10 offen nt
    s_add_u32 s10, s10, 8192
    buffer_load_dwordx4 v[132:135], v10, s[40:43], s10 offen nt
    s_add_u32 s10, s10, 466944
    buffer_load_dwordx4 v[136:139], v10, s[40:43], s10 offen nt
    s_add_u32 s10, s10, 8192
    buffer_load_dwordx4 v[140:143], v10, s[40:43], s10 offen nt
    s_add_u32 s10, s10, 8192
    buffer_load_dwordx4 v[144:147], v10, s[40:43], s10 offen nt
    s_add_u32 s10, s10, 8192
    buffer_load_dwordx4 v[148:151], v10, s[40:43], s10 offen nt
    s_add_u32 s10, s10, 8192
    buffer_load_dwordx4 v[152:155], v10, s[40:43], s10 offen nt
    s_add_u32 s10, s10, 8192
    buffer_load_dwordx4 v[156:159], v10, s[40:43], s10 offen nt
    s_add_u32 s10, s10, 8192
    buffer_load_dwordx4 v[160:163], v10, s[40:43], s10 offen nt
    s_add_u32 s10, s10, 8192
    buffer_load_dwordx4 v[164:167], v10, s[40:43], s10 offen nt
    s_add_u32 s10, s10, 466944
    buffer_load_dwordx4 v[168:171], v10, s[40:43], s10 offen nt
    s_add_u32 s10, s10, 8192
    buffer_load_dwordx4 v[172:175], v10, s[40:43], s10 offen nt
    s_add_u32 s10, s10, 8192
    buffer_load_dwordx4 v[176:179], v10, s[40:43], s10 offen nt
    s_add_u32 s10, s10, 8192
    buffer_load_dwordx4 v[180:183], v10, s[40:43], s10 offen nt
    s_add_u32 s10, s10, 8192
    buffer_load_dwordx4 v[184:187], v10, s[40:43], s10 offen nt
    s_add_u32 s10, s10, 8192
    buffer_load_dwordx4 v[188:191], v10, s[40:43], s10 offen nt
    s_add_u32 s10, s10, 8192
    buffer_load_dwordx4 v[192:195], v10, s[40:43], s10 offen nt
    s_add_u32 s10, s10, 8192
    buffer_load_dwordx4 v[196:199], v10, s[40:43], s10 offen nt
    s_barrier
    s_mov_b32 s48, s38
    s_mov_b32 s49, s39
    s_mov_b32 s50, 0x4000000
    s_mov_b32 s51, 0x20000
    s_mov_b32 s64, 0x05040100
    s_mov_b32 s65, 0x07060302
    s_mov_b32 s66, 0xffff0000
    s_mov_b32 s67, 0x3fb8aa3b
    s_mov_b32 s68, 0x3db504f3
    s_movk_i32 s69, 0xff
    s_mov_b32 s101, 0
    s_mov_b32 s9, 16384
    s_lshl_b32 s10, s7, 15
    s_lshl_b32 s11, s6, 8
    s_add_u32 s10, s10, s11
    s_waitcnt vmcnt(32)
    v_lshlrev_b32 v36, 16, v16
    v_and_b32 v37, s66, v16
    v_lshlrev_b32 v38, 16, v17
    v_and_b32 v39, s66, v17
    v_lshlrev_b32 v40, 16, v18
    v_and_b32 v41, s66, v18
    v_lshlrev_b32 v42, 16, v19
    v_and_b32 v43, s66, v19
    v_lshlrev_b32 v44, 16, v20
    v_and_b32 v45, s66, v20
    v_lshlrev_b32 v46, 16, v21
    v_and_b32 v47, s66, v21
    v_lshlrev_b32 v48, 16, v22
    v_and_b32 v49, s66, v22
    v_lshlrev_b32 v50, 16, v23
    v_and_b32 v51, s66, v23
    v_lshlrev_b32 v52, 16, v24
    v_and_b32 v53, s66, v24
    v_lshlrev_b32 v54, 16, v25
    v_and_b32 v55, s66, v25
    v_lshlrev_b32 v56, 16, v26
    v_and_b32 v57, s66, v26
    v_lshlrev_b32 v58, 16, v27
    v_and_b32 v59, s66, v27
    v_lshlrev_b32 v60, 16, v28
    v_and_b32 v61, s66, v28
    v_lshlrev_b32 v62, 16, v29
    v_and_b32 v63, s66, v29
    v_lshlrev_b32 v64, 16, v30
    v_and_b32 v65, s66, v30
    v_lshlrev_b32 v66, 16, v31
    v_and_b32 v67, s66, v31
    v_add_f32 v16, v36, v40
    v_add_f32 v17, v37, v41
    v_add_f32 v18, v38, v42
    v_add_f32 v19, v39, v43
    v_add_f32 v16, v16, v44
    v_add_f32 v17, v17, v45
    v_add_f32 v18, v18, v46
    v_add_f32 v19, v19, v47
    v_add_f32 v16, v16, v48
    v_add_f32 v17, v17, v49
    v_add_f32 v18, v18, v50
    v_add_f32 v19, v19, v51
    v_add_f32 v16, v16, v52
    v_add_f32 v17, v17, v53
    v_add_f32 v18, v18, v54
    v_add_f32 v19, v19, v55
    v_add_f32 v16, v16, v56
    v_add_f32 v17, v17, v57
    v_add_f32 v18, v18, v58
    v_add_f32 v19, v19, v59
    v_add_f32 v16, v16, v60
    v_add_f32 v17, v17, v61
    v_add_f32 v18, v18, v62
    v_add_f32 v19, v19, v63
    v_add_f32 v16, v16, v64
    v_add_f32 v17, v17, v65
    v_add_f32 v18, v18, v66
    v_add_f32 v19, v19, v67
    v_add_f32 v11, v16, v17
    v_add_f32 v13, v18, v19
    v_add_f32 v11, v11, v13
    s_nop 1
    v_add_f32_dpp v11, v11, v11 row_ror:8 row_mask:0xf bank_mask:0xf
    s_nop 1
    v_add_f32_dpp v11, v11, v11 row_ror:4 row_mask:0xf bank_mask:0xf
    s_nop 1
    v_add_f32_dpp v11, v11, v11 row_ror:2 row_mask:0xf bank_mask:0xf
    s_nop 1
    v_add_f32_dpp v11, v11, v11 row_ror:1 row_mask:0xf bank_mask:0xf
    v_mov_b32 v12, v11
    s_nop 1
    v_permlane16_swap_b32 v11, v12
    v_add_f32 v11, v11, v12
    v_mul_f32 v11, 0x3a800000, v11
    v_sub_f32 v36, v36, v11
    v_sub_f32 v37, v37, v11
    v_sub_f32 v38, v38, v11
    v_sub_f32 v39, v39, v11
    v_sub_f32 v40, v40, v11
    v_sub_f32 v41, v41, v11
    v_sub_f32 v42, v42, v11
    v_sub_f32 v43, v43, v11
    v_sub_f32 v44, v44, v11
    v_sub_f32 v45, v45, v11
    v_sub_f32 v46, v46, v11
    v_sub_f32 v47, v47, v11
    v_sub_f32 v48, v48, v11
    v_sub_f32 v49, v49, v11
    v_sub_f32 v50, v50, v11
    v_sub_f32 v51, v51, v11
    v_sub_f32 v52, v52, v11
    v_sub_f32 v53, v53, v11
    v_sub_f32 v54, v54, v11
    v_sub_f32 v55, v55, v11
    v_sub_f32 v56, v56, v11
    v_sub_f32 v57, v57, v11
    v_sub_f32 v58, v58, v11
    v_sub_f32 v59, v59, v11
    v_sub_f32 v60, v60, v11
    v_sub_f32 v61, v61, v11
    v_sub_f32 v62, v62, v11
    v_sub_f32 v63, v63, v11
    v_sub_f32 v64, v64, v11
    v_sub_f32 v65, v65, v11
    v_sub_f32 v66, v66, v11
    v_sub_f32 v67, v67, v11
    v_mul_f32 v16, v36, v36
    v_mul_f32 v17, v37, v37
    v_mul_f32 v18, v38, v38
    v_mul_f32 v19, v39, v39
    v_fmac_f32 v16, v40, v40
    v_fmac_f32 v17, v41, v41
    v_fmac_f32 v18, v42, v42
    v_fmac_f32 v19, v43, v43
    v_fmac_f32 v16, v44, v44
    v_fmac_f32 v17, v45, v45
    v_fmac_f32 v18, v46, v46
    v_fmac_f32 v19, v47, v47
    v_fmac_f32 v16, v48, v48
    v_fmac_f32 v17, v49, v49
    v_fmac_f32 v18, v50, v50
    v_fmac_f32 v19, v51, v51
    v_fmac_f32 v16, v52, v52
    v_fmac_f32 v17, v53, v53
    v_fmac_f32 v18, v54, v54
    v_fmac_f32 v19, v55, v55
    v_fmac_f32 v16, v56, v56
    v_fmac_f32 v17, v57, v57
    v_fmac_f32 v18, v58, v58
    v_fmac_f32 v19, v59, v59
    v_fmac_f32 v16, v60, v60
    v_fmac_f32 v17, v61, v61
    v_fmac_f32 v18, v62, v62
    v_fmac_f32 v19, v63, v63
    v_fmac_f32 v16, v64, v64
    v_fmac_f32 v17, v65, v65
    v_fmac_f32 v18, v66, v66
    v_fmac_f32 v19, v67, v67
    v_add_f32 v12, v16, v17
    v_add_f32 v13, v18, v19
    v_add_f32 v12, v12, v13
    s_nop 1
    v_add_f32_dpp v12, v12, v12 row_ror:8 row_mask:0xf bank_mask:0xf
    s_nop 1
    v_add_f32_dpp v12, v12, v12 row_ror:4 row_mask:0xf bank_mask:0xf
    s_nop 1
    v_add_f32_dpp v12, v12, v12 row_ror:2 row_mask:0xf bank_mask:0xf
    s_nop 1
    v_add_f32_dpp v12, v12, v12 row_ror:1 row_mask:0xf bank_mask:0xf
    v_mov_b32 v13, v12
    s_nop 1
    v_permlane16_swap_b32 v12, v13
    v_add_f32 v12, v12, v13
    v_mul_f32 v12, 0x3a800000, v12
    v_cvt_pk_bf16_f32 v11, v11, v11
    v_lshlrev_b32 v11, 16, v11
    v_cvt_pk_bf16_f32 v12, v12, v12
    v_lshlrev_b32 v12, 16, v12
    v_add_f32 v12, 0x3727c5ac, v12
    v_cvt_pk_bf16_f32 v12, v12, v12
    v_lshlrev_b32 v12, 16, v12
    v_sqrt_f32 v12, v12
    s_nop 0
    v_cvt_pk_bf16_f32 v12, v12, v12
    v_lshlrev_b32 v12, 16, v12
    v_rcp_f32 v13, v12
    v_lshlrev_b32 v36, 16, v32
    v_and_b32 v37, s66, v32
    v_lshlrev_b32 v38, 16, v33
    v_and_b32 v39, s66, v33
    v_lshlrev_b32 v40, 16, v34
    v_and_b32 v41, s66, v34
    v_lshlrev_b32 v42, 16, v35
    v_and_b32 v43, s66, v35
    v_sub_f32 v36, v36, v11
    v_sub_f32 v37, v37, v11
    v_sub_f32 v38, v38, v11
    v_sub_f32 v39, v39, v11
    v_sub_f32 v40, v40, v11
    v_sub_f32 v41, v41, v11
    v_sub_f32 v42, v42, v11
    v_sub_f32 v43, v43, v11
    v_cvt_pk_bf16_f32 v32, v36, v37
    v_cvt_pk_bf16_f32 v33, v38, v39
    v_cvt_pk_bf16_f32 v34, v40, v41
    v_cvt_pk_bf16_f32 v35, v42, v43
    v_lshlrev_b32 v36, 16, v32
    v_and_b32 v37, s66, v32
    v_lshlrev_b32 v38, 16, v33
    v_and_b32 v39, s66, v33
    v_lshlrev_b32 v40, 16, v34
    v_and_b32 v41, s66, v34
    v_lshlrev_b32 v42, 16, v35
    v_and_b32 v43, s66, v35
    v_mul_f32 v44, v36, v13
    v_mul_f32 v45, v37, v13
    v_mul_f32 v46, v38, v13
    v_mul_f32 v47, v39, v13
    v_mul_f32 v48, v40, v13
    v_mul_f32 v49, v41, v13
    v_mul_f32 v50, v42, v13
    v_mul_f32 v51, v43, v13
    v_fma_f32 v36, -v44, v12, v36
    v_fma_f32 v37, -v45, v12, v37
    v_fma_f32 v38, -v46, v12, v38
    v_fma_f32 v39, -v47, v12, v39
    v_fma_f32 v40, -v48, v12, v40
    v_fma_f32 v41, -v49, v12, v41
    v_fma_f32 v42, -v50, v12, v42
    v_fma_f32 v43, -v51, v12, v43
    v_fmac_f32 v44, v36, v13
    v_fmac_f32 v45, v37, v13
    v_fmac_f32 v46, v38, v13
    v_fmac_f32 v47, v39, v13
    v_fmac_f32 v48, v40, v13
    v_fmac_f32 v49, v41, v13
    v_fmac_f32 v50, v42, v13
    v_fmac_f32 v51, v43, v13
    v_cvt_pk_bf16_f32 v32, v44, v45
    v_cvt_pk_bf16_f32 v33, v46, v47
    v_cvt_pk_bf16_f32 v34, v48, v49
    v_cvt_pk_bf16_f32 v35, v50, v51
    v_lshlrev_b32 v11, 4, v0
    ds_write_b128 v11, v[32:35] offset:0
    ds_write_b32 v14, v14 offset:3492
    s_waitcnt lgkmcnt(0)
    s_add_u32 s14, s14, 1
    s_and_b32 s14, s14, 0xff
    v_mov_b32 v15, s14
L_S_gemv:
    s_mov_b32 s69, 63
    v_bfe_u32 v11, v4, 2, 1
    v_lshlrev_b32 v11, 9, v11
    v_lshl_add_u32 v11, v5, 5, v11
    v_and_b32 v12, 1, v4
    v_lshl_add_u32 v11, v12, 4, v11
    ds_read_b128 v[36:39], v11 offset:0
    ds_read_b128 v[40:43], v11 offset:128
    ds_read_b128 v[44:47], v11 offset:256
    ds_read_b128 v[48:51], v11 offset:384
    v_mul_u32_u24 v12, s9, v5
    v_lshl_add_u32 v12, v9, 5, v12
    v_lshl_add_u32 v12, v8, 4, v12
    s_waitcnt lgkmcnt(0)
    s_waitcnt vmcnt(24)
    v_perm_b32 v232, v76, v72, s64
    v_perm_b32 v233, v84, v80, s64
    v_perm_b32 v234, v92, v88, s64
    v_perm_b32 v235, v100, v96, s64
    v_perm_b32 v236, v76, v72, s65
    v_perm_b32 v237, v84, v80, s65
    v_perm_b32 v238, v92, v88, s65
    v_perm_b32 v239, v100, v96, s65
    v_perm_b32 v240, v77, v73, s64
    v_perm_b32 v241, v85, v81, s64
    v_perm_b32 v242, v93, v89, s64
    v_perm_b32 v243, v101, v97, s64
    v_perm_b32 v244, v77, v73, s65
    v_perm_b32 v245, v85, v81, s65
    v_perm_b32 v246, v93, v89, s65
    v_perm_b32 v247, v101, v97, s65
    v_mfma_f32_16x16x32_bf16 v[200:203], v[36:39], v[232:235], 0
    v_mfma_f32_16x16x32_bf16 v[204:207], v[36:39], v[236:239], 0
    v_perm_b32 v232, v78, v74, s64
    v_perm_b32 v233, v86, v82, s64
    v_perm_b32 v234, v94, v90, s64
    v_perm_b32 v235, v102, v98, s64
    v_perm_b32 v236, v78, v74, s65
    v_perm_b32 v237, v86, v82, s65
    v_perm_b32 v238, v94, v90, s65
    v_perm_b32 v239, v102, v98, s65
    v_mfma_f32_16x16x32_bf16 v[208:211], v[36:39], v[240:243], 0
    v_mfma_f32_16x16x32_bf16 v[212:215], v[36:39], v[244:247], 0
    v_perm_b32 v240, v79, v75, s64
    v_perm_b32 v241, v87, v83, s64
    v_perm_b32 v242, v95, v91, s64
    v_perm_b32 v243, v103, v99, s64
    v_perm_b32 v244, v79, v75, s65
    v_perm_b32 v245, v87, v83, s65
    v_perm_b32 v246, v95, v91, s65
    v_perm_b32 v247, v103, v99, s65
    v_mfma_f32_16x16x32_bf16 v[216:219], v[36:39], v[232:235], 0
    v_mfma_f32_16x16x32_bf16 v[220:223], v[36:39], v[236:239], 0
    v_mfma_f32_16x16x32_bf16 v[224:227], v[36:39], v[240:243], 0
    v_mfma_f32_16x16x32_bf16 v[228:231], v[36:39], v[244:247], 0
    s_waitcnt vmcnt(16)
    v_perm_b32 v232, v108, v104, s64
    v_perm_b32 v233, v116, v112, s64
    v_perm_b32 v234, v124, v120, s64
    v_perm_b32 v235, v132, v128, s64
    v_perm_b32 v236, v108, v104, s65
    v_perm_b32 v237, v116, v112, s65
    v_perm_b32 v238, v124, v120, s65
    v_perm_b32 v239, v132, v128, s65
    v_perm_b32 v240, v109, v105, s64
    v_perm_b32 v241, v117, v113, s64
    v_perm_b32 v242, v125, v121, s64
    v_perm_b32 v243, v133, v129, s64
    v_perm_b32 v244, v109, v105, s65
    v_perm_b32 v245, v117, v113, s65
    v_perm_b32 v246, v125, v121, s65
    v_perm_b32 v247, v133, v129, s65
    v_mfma_f32_16x16x32_bf16 v[200:203], v[40:43], v[232:235], v[200:203]
    v_mfma_f32_16x16x32_bf16 v[204:207], v[40:43], v[236:239], v[204:207]
    v_perm_b32 v232, v110, v106, s64
    v_perm_b32 v233, v118, v114, s64
    v_perm_b32 v234, v126, v122, s64
    v_perm_b32 v235, v134, v130, s64
    v_perm_b32 v236, v110, v106, s65
    v_perm_b32 v237, v118, v114, s65
    v_perm_b32 v238, v126, v122, s65
    v_perm_b32 v239, v134, v130, s65
    v_mfma_f32_16x16x32_bf16 v[208:211], v[40:43], v[240:243], v[208:211]
    v_mfma_f32_16x16x32_bf16 v[212:215], v[40:43], v[244:247], v[212:215]
    v_perm_b32 v240, v111, v107, s64
    v_perm_b32 v241, v119, v115, s64
    v_perm_b32 v242, v127, v123, s64
    v_perm_b32 v243, v135, v131, s64
    v_perm_b32 v244, v111, v107, s65
    v_perm_b32 v245, v119, v115, s65
    v_perm_b32 v246, v127, v123, s65
    v_perm_b32 v247, v135, v131, s65
    v_mfma_f32_16x16x32_bf16 v[216:219], v[40:43], v[232:235], v[216:219]
    v_mfma_f32_16x16x32_bf16 v[220:223], v[40:43], v[236:239], v[220:223]
    v_mfma_f32_16x16x32_bf16 v[224:227], v[40:43], v[240:243], v[224:227]
    v_mfma_f32_16x16x32_bf16 v[228:231], v[40:43], v[244:247], v[228:231]
    s_waitcnt vmcnt(8)
    v_perm_b32 v232, v140, v136, s64
    v_perm_b32 v233, v148, v144, s64
    v_perm_b32 v234, v156, v152, s64
    v_perm_b32 v235, v164, v160, s64
    v_perm_b32 v236, v140, v136, s65
    v_perm_b32 v237, v148, v144, s65
    v_perm_b32 v238, v156, v152, s65
    v_perm_b32 v239, v164, v160, s65
    v_perm_b32 v240, v141, v137, s64
    v_perm_b32 v241, v149, v145, s64
    v_perm_b32 v242, v157, v153, s64
    v_perm_b32 v243, v165, v161, s64
    v_perm_b32 v244, v141, v137, s65
    v_perm_b32 v245, v149, v145, s65
    v_perm_b32 v246, v157, v153, s65
    v_perm_b32 v247, v165, v161, s65
    v_mfma_f32_16x16x32_bf16 v[200:203], v[44:47], v[232:235], v[200:203]
    v_mfma_f32_16x16x32_bf16 v[204:207], v[44:47], v[236:239], v[204:207]
    v_perm_b32 v232, v142, v138, s64
    v_perm_b32 v233, v150, v146, s64
    v_perm_b32 v234, v158, v154, s64
    v_perm_b32 v235, v166, v162, s64
    v_perm_b32 v236, v142, v138, s65
    v_perm_b32 v237, v150, v146, s65
    v_perm_b32 v238, v158, v154, s65
    v_perm_b32 v239, v166, v162, s65
    v_mfma_f32_16x16x32_bf16 v[208:211], v[44:47], v[240:243], v[208:211]
    v_mfma_f32_16x16x32_bf16 v[212:215], v[44:47], v[244:247], v[212:215]
    v_perm_b32 v240, v143, v139, s64
    v_perm_b32 v241, v151, v147, s64
    v_perm_b32 v242, v159, v155, s64
    v_perm_b32 v243, v167, v163, s64
    v_perm_b32 v244, v143, v139, s65
    v_perm_b32 v245, v151, v147, s65
    v_perm_b32 v246, v159, v155, s65
    v_perm_b32 v247, v167, v163, s65
    v_mfma_f32_16x16x32_bf16 v[216:219], v[44:47], v[232:235], v[216:219]
    v_mfma_f32_16x16x32_bf16 v[220:223], v[44:47], v[236:239], v[220:223]
    v_mfma_f32_16x16x32_bf16 v[224:227], v[44:47], v[240:243], v[224:227]
    v_mfma_f32_16x16x32_bf16 v[228:231], v[44:47], v[244:247], v[228:231]
    s_waitcnt vmcnt(0)
    v_perm_b32 v232, v172, v168, s64
    v_perm_b32 v233, v180, v176, s64
    v_perm_b32 v234, v188, v184, s64
    v_perm_b32 v235, v196, v192, s64
    v_perm_b32 v236, v172, v168, s65
    v_perm_b32 v237, v180, v176, s65
    v_perm_b32 v238, v188, v184, s65
    v_perm_b32 v239, v196, v192, s65
    v_perm_b32 v240, v173, v169, s64
    v_perm_b32 v241, v181, v177, s64
    v_perm_b32 v242, v189, v185, s64
    v_perm_b32 v243, v197, v193, s64
    v_perm_b32 v244, v173, v169, s65
    v_perm_b32 v245, v181, v177, s65
    v_perm_b32 v246, v189, v185, s65
    v_perm_b32 v247, v197, v193, s65
    v_mfma_f32_16x16x32_bf16 v[200:203], v[48:51], v[232:235], v[200:203]
    v_mfma_f32_16x16x32_bf16 v[204:207], v[48:51], v[236:239], v[204:207]
    v_perm_b32 v232, v174, v170, s64
    v_perm_b32 v233, v182, v178, s64
    v_perm_b32 v234, v190, v186, s64
    v_perm_b32 v235, v198, v194, s64
    v_perm_b32 v236, v174, v170, s65
    v_perm_b32 v237, v182, v178, s65
    v_perm_b32 v238, v190, v186, s65
    v_perm_b32 v239, v198, v194, s65
    v_mfma_f32_16x16x32_bf16 v[208:211], v[48:51], v[240:243], v[208:211]
    v_mfma_f32_16x16x32_bf16 v[212:215], v[48:51], v[244:247], v[212:215]
    v_perm_b32 v240, v175, v171, s64
    v_perm_b32 v241, v183, v179, s64
    v_perm_b32 v242, v191, v187, s64
    v_perm_b32 v243, v199, v195, s64
    v_perm_b32 v244, v175, v171, s65
    v_perm_b32 v245, v183, v179, s65
    v_perm_b32 v246, v191, v187, s65
    v_perm_b32 v247, v199, v195, s65
    v_mfma_f32_16x16x32_bf16 v[216:219], v[48:51], v[232:235], v[216:219]
    v_mfma_f32_16x16x32_bf16 v[220:223], v[48:51], v[236:239], v[220:223]
    v_mfma_f32_16x16x32_bf16 v[224:227], v[48:51], v[240:243], v[224:227]
    v_mfma_f32_16x16x32_bf16 v[228:231], v[48:51], v[244:247], v[228:231]
    s_nop 3
    v_add_f32_dpp v232, v201, v200 row_ror:8 row_mask:0xf bank_mask:0x3
    v_add_f32_dpp v233, v205, v204 row_ror:8 row_mask:0xf bank_mask:0x3
    v_add_f32_dpp v234, v209, v208 row_ror:8 row_mask:0xf bank_mask:0x3
    v_add_f32_dpp v235, v213, v212 row_ror:8 row_mask:0xf bank_mask:0x3
    v_add_f32_dpp v232, v216, v217 row_ror:8 row_mask:0xf bank_mask:0xc
    v_add_f32_dpp v233, v220, v221 row_ror:8 row_mask:0xf bank_mask:0xc
    s_nop 0
    v_add_f32_dpp v234, v224, v225 row_ror:8 row_mask:0xf bank_mask:0xc
    s_nop 0
    v_add_f32_dpp v235, v228, v229 row_ror:8 row_mask:0xf bank_mask:0xc
    v_add_u32 v232, 32, v232
    v_bfi_b32 v232, s69, v15, v232
    v_add_u32 v233, 32, v233
    v_bfi_b32 v233, s69, v15, v233
    v_add_u32 v234, 32, v234
    v_bfi_b32 v234, s69, v15, v234
    v_add_u32 v235, 32, v235
    v_bfi_b32 v235, s69, v15, v235
    s_mov_b32 exec_hi, 0
    s_cmp_eq_u32 s101, 1
    s_cbranch_scc1 L_stf1
    buffer_store_dwordx4 v[232:235], v12, s[48:51], s10 offen sc1
    s_branch L_std2
L_stf1:
    buffer_store_dwordx4 v[232:235], v12, s[48:51], s10 offen
L_std2:
    s_mov_b64 exec, -1
    s_cmp_eq_u32 s3, 1
    s_cbranch_scc1 L_S_END
    s_cmp_eq_u32 s3, 2
    s_cbranch_scc1 L_S2_h
    s_and_b32 s62, s14, 63
    v_lshlrev_b32 v6, 4, v0
    s_lshl_b32 s10, s96, 12
    s_add_u32 s11, s10, 32768
    s_add_u32 s12, s10, 65536
    s_add_u32 s13, s10, 98304
    v_lshrrev_b32 v7, 5, v0
    v_mul_u32_u24 v7, 272, v7
    v_and_b32 v11, 31, v0
    v_lshl_add_u32 v7, v11, 3, v7
    s_mov_b32 s15, 16000000
L_poll3:
    ds_read_b32 v16, v14 offset:3496
    s_waitcnt lgkmcnt(0)
    v_cmp_eq_u32 vcc, 0, v16
    s_cmp_eq_u64 vcc, -1
    s_cbranch_scc1 L_pdone4
    s_sub_u32 s15, s15, 1
    s_cbranch_scc1 L_pdone4
    s_sleep 2
    s_branch L_poll3
L_pdone4:
    s_mov_b32 s15, 2000000
L_poll5:
    buffer_load_dwordx4 v[32:35], v6, s[48:51], s10 offen offset:0 sc1
    buffer_load_dwordx4 v[36:39], v6, s[48:51], s10 offen offset:1024 sc1
    buffer_load_dwordx4 v[40:43], v6, s[48:51], s10 offen offset:2048 sc1
    buffer_load_dwordx4 v[44:47], v6, s[48:51], s10 offen offset:3072 sc1
    buffer_load_dwordx4 v[48:51], v6, s[48:51], s11 offen offset:0 sc1
    buffer_load_dwordx4 v[52:55], v6, s[48:51], s11 offen offset:1024 sc1
    buffer_load_dwordx4 v[56:59], v6, s[48:51], s11 offen offset:2048 sc1
    buffer_load_dwordx4 v[60:63], v6, s[48:51], s11 offen offset:3072 sc1
    buffer_load_dwordx4 v[64:67], v6, s[48:51], s12 offen offset:0 sc1
    buffer_load_dwordx4 v[68:71], v6, s[48:51], s12 offen offset:1024 sc1
    buffer_load_dwordx4 v[72:75], v6, s[48:51], s12 offen offset:2048 sc1
    buffer_load_dwordx4 v[76:79], v6, s[48:51], s12 offen offset:3072 sc1
    buffer_load_dwordx4 v[80:83], v6, s[48:51], s13 offen offset:0 sc1
    buffer_load_dwordx4 v[84:87], v6, s[48:51], s13 offen offset:1024 sc1
    buffer_load_dwordx4 v[88:91], v6, s[48:51], s13 offen offset:2048 sc1
    buffer_load_dwordx4 v[92:95], v6, s[48:51], s13 offen offset:3072 sc1
    s_waitcnt vmcnt(0)
    v_xor_b32 v32, s62, v32
    v_xor_b32 v33, s62, v33
    v_xor_b32 v34, s62, v34
    v_xor_b32 v35, s62, v35
    v_xor_b32 v36, s62, v36
    v_xor_b32 v37, s62, v37
    v_xor_b32 v38, s62, v38
    v_xor_b32 v39, s62, v39
    v_xor_b32 v40, s62, v40
    v_xor_b32 v41, s62, v41
    v_xor_b32 v42, s62, v42
    v_xor_b32 v43, s62, v43
    v_xor_b32 v44, s62, v44
    v_xor_b32 v45, s62, v45
    v_xor_b32 v46, s62, v46
    v_xor_b32 v47, s62, v47
    v_xor_b32 v48, s62, v48
    v_xor_b32 v49, s62, v49
    v_xor_b32 v50, s62, v50
    v_xor_b32 v51, s62, v51
    v_xor_b32 v52, s62, v52
    v_xor_b32 v53, s62, v53
    v_xor_b32 v54, s62, v54
    v_xor_b32 v55, s62, v55
    v_xor_b32 v56, s62, v56
    v_xor_b32 v57, s62, v57
    v_xor_b32 v58, s62, v58
    v_xor_b32 v59, s62, v59
    v_xor_b32 v60, s62, v60
    v_xor_b32 v61, s62, v61
    v_xor_b32 v62, s62, v62
    v_xor_b32 v63, s62, v63
    v_xor_b32 v64, s62, v64
    v_xor_b32 v65, s62, v65
    v_xor_b32 v66, s62, v66
    v_xor_b32 v67, s62, v67
    v_xor_b32 v68, s62, v68
    v_xor_b32 v69, s62, v69
    v_xor_b32 v70, s62, v70
    v_xor_b32 v71, s62, v71
    v_xor_b32 v72, s62, v72
    v_xor_b32 v73, s62, v73
    v_xor_b32 v74, s62, v74
    v_xor_b32 v75, s62, v75
    v_xor_b32 v76, s62, v76
    v_xor_b32 v77, s62, v77
    v_xor_b32 v78, s62, v78
    v_xor_b32 v79, s62, v79
    v_xor_b32 v80, s62, v80
    v_xor_b32 v81, s62, v81
    v_xor_b32 v82, s62, v82
    v_xor_b32 v83, s62, v83
    v_xor_b32 v84, s62, v84
    v_xor_b32 v85, s62, v85
    v_xor_b32 v86, s62, v86
    v_xor_b32 v87, s62, v87
    v_xor_b32 v88, s62, v88
    v_xor_b32 v89, s62, v89
    v_xor_b32 v90, s62, v90
    v_xor_b32 v91, s62, v91
    v_xor_b32 v92, s62, v92
    v_xor_b32 v93, s62, v93
    v_xor_b32 v94, s62, v94
    v_xor_b32 v95, s62, v95
    v_or3_b32 v11, v32, v33, v34
    v_or3_b32 v12, v35, v36, v37
    v_or3_b32 v11, v11, v38, v39
    v_or3_b32 v12, v12, v40, v41
    v_or3_b32 v11, v11, v42, v43
    v_or3_b32 v12, v12, v44, v45
    v_or3_b32 v11, v11, v46, v47
    v_or3_b32 v12, v12, v48, v49
    v_or3_b32 v11, v11, v50, v51
    v_or3_b32 v12, v12, v52, v53
    v_or3_b32 v11, v11, v54, v55
    v_or3_b32 v12, v12, v56, v57
    v_or3_b32 v11, v11, v58, v59
    v_or3_b32 v12, v12, v60, v61
    v_or3_b32 v11, v11, v62, v63
    v_or3_b32 v12, v12, v64, v65
    v_or3_b32 v11, v11, v66, v67
    v_or3_b32 v12, v12, v68, v69
    v_or3_b32 v11, v11, v70, v71
    v_or3_b32 v12, v12, v72, v73
    v_or3_b32 v11, v11, v74, v75
    v_or3_b32 v12, v12, v76, v77
    v_or3_b32 v11, v11, v78, v79
    v_or3_b32 v12, v12, v80, v81
    v_or3_b32 v11, v11, v82, v83
    v_or3_b32 v12, v12, v84, v85
    v_or3_b32 v11, v11, v86, v87
    v_or3_b32 v12, v12, v88, v89
    v_or3_b32 v11, v11, v90, v91
    v_or3_b32 v12, v12, v92, v93
    v_or3_b32 v11, v11, v94, v95
    v_or_b32 v11, v11, v12
    v_and_b32 v11, 63, v11
    v_cmp_eq_u32 vcc, 0, v11
    s_cmp_eq_u64 vcc, -1
    s_cbranch_scc1 L_pdone6
    s_sub_u32 s15, s15, 1
    s_cbranch_scc1 L_pdone6
    s_branch L_poll5
L_pdone6:
    v_add_f32 v32, v32, v48
    v_add_f32 v64, v64, v80
    v_add_f32 v33, v33, v49
    v_add_f32 v65, v65, v81
    v_add_f32 v34, v34, v50
    v_add_f32 v66, v66, v82
    v_add_f32 v35, v35, v51
    v_add_f32 v67, v67, v83
    v_add_f32 v36, v36, v52
    v_add_f32 v68, v68, v84
    v_add_f32 v37, v37, v53
    v_add_f32 v69, v69, v85
    v_add_f32 v38, v38, v54
    v_add_f32 v70, v70, v86
    v_add_f32 v39, v39, v55
    v_add_f32 v71, v71, v87
    v_add_f32 v40, v40, v56
    v_add_f32 v72, v72, v88
    v_add_f32 v41, v41, v57
    v_add_f32 v73, v73, v89
    v_add_f32 v42, v42, v58
    v_add_f32 v74, v74, v90
    v_add_f32 v43, v43, v59
    v_add_f32 v75, v75, v91
    v_add_f32 v44, v44, v60
    v_add_f32 v76, v76, v92
    v_add_f32 v45, v45, v61
    v_add_f32 v77, v77, v93
    v_add_f32 v46, v46, v62
    v_add_f32 v78, v78, v94
    v_add_f32 v47, v47, v63
    v_add_f32 v79, v79, v95
    v_add_f32 v32, v32, v64
    v_add_f32 v33, v33, v65
    v_add_f32 v34, v34, v66
    v_add_f32 v35, v35, v67
    v_add_f32 v36, v36, v68
    v_add_f32 v37, v37, v69
    v_add_f32 v38, v38, v70
    v_add_f32 v39, v39, v71
    v_add_f32 v40, v40, v72
    v_add_f32 v41, v41, v73
    v_add_f32 v42, v42, v74
    v_add_f32 v43, v43, v75
    v_add_f32 v44, v44, v76
    v_add_f32 v45, v45, v77
    v_add_f32 v46, v46, v78
    v_add_f32 v47, v47, v79
    v_cvt_pk_bf16_f32 v48, v32, v33
    v_cvt_pk_bf16_f32 v49, v34, v35
    ds_write_b64 v7, v[48:49] offset:1024
    v_cvt_pk_bf16_f32 v50, v36, v37
    v_cvt_pk_bf16_f32 v51, v38, v39
    ds_write_b64 v7, v[50:51] offset:1568
    v_cvt_pk_bf16_f32 v52, v40, v41
    v_cvt_pk_bf16_f32 v53, v42, v43
    ds_write_b64 v7, v[52:53] offset:2112
    v_cvt_pk_bf16_f32 v54, v44, v45
    v_cvt_pk_bf16_f32 v55, v46, v47
    ds_write_b64 v7, v[54:55] offset:2656
    ds_write_b32 v14, v14 offset:3488
    s_lshl_b32 s7, s97, 9
    s_add_u32 s7, s7, 491520
    s_mov_b32 s56, s16
    s_mov_b32 s57, s17
    s_mov_b32 s58, 0x1000
    s_mov_b32 s59, 0x20000
    s_mov_b32 s60, s34
    s_mov_b32 s61, s35
    s_mov_b32 s62, 0x1000
    s_mov_b32 s63, 0x20000
    v_and_b32 v10, 1, v0
    v_lshl_add_u32 v10, v10, 2, v5
    v_lshlrev_b32 v10, 1, v10
    s_lshr_b32 s12, s97, 4
    s_lshl_b32 s12, s12, 11
    s_bfe_u32 s4, s97, 0x10003
    s_lshl1_add_u32 s11, s96, s4
    s_lshl_b32 s11, s11, 7
    s_add_u32 s12, s12, s11
    s_and_b32 s11, s97, 7
    s_lshl_b32 s11, s11, 4
    s_add_u32 s12, s12, s11
    buffer_load_ushort v36, v10, s[56:59], s12 offen
    v_lshrrev_b32 v9, 1, v0
    v_lshlrev_b32 v9, 7, v9
    v_and_b32 v6, 1, v0
    v_lshl_add_u32 v9, v6, 4, v9
    s_lshr_b32 s13, s99, 2
    s_lshl_b32 s13, s13, 13
    s_and_b32 s11, s97, 3
    s_lshl_b32 s11, s11, 5
    s_add_u32 s13, s13, s11
    s_add_u32 s13, s13, 1572864
    s_add_u32 s8, s13, 4096
    v_lshrrev_b32 v11, 5, v0
    v_lshlrev_b32 v11, 14, v11
    v_and_b32 v6, 31, v0
    v_lshl_add_u32 v11, v6, 4, v11
    v_lshlrev_b32 v6, 3, v0
    s_mov_b32 s15, 16000000
L_poll7:
    ds_read_b128 v[16:19], v14 offset:3536
    s_waitcnt lgkmcnt(0)
    v_or3_b32 v16, v16, v17, v18
    v_or_b32 v16, v16, v19
    v_cmp_eq_u32 vcc, 0, v16
    s_cmp_eq_u64 vcc, -1
    s_cbranch_scc1 L_pdone8
    s_sub_u32 s15, s15, 1
    s_cbranch_scc1 L_pdone8
    s_sleep 1
    s_branch L_poll7
L_pdone8:
    s_mov_b32 s15, 2000000
L_poll9:
    buffer_load_dwordx4 v[100:103], v11, s[48:51], s7 offen sc1
    s_waitcnt vmcnt(0)
    v_xor_b32 v100, s14, v100
    v_xor_b32 v101, s14, v101
    v_xor_b32 v102, s14, v102
    v_xor_b32 v103, s14, v103
    v_or3_b32 v12, v100, v101, v102
    v_or_b32 v12, v12, v103
    v_and_b32 v12, 255, v12
    v_cmp_eq_u32 vcc, 0, v12
    s_cmp_eq_u64 vcc, -1
    s_cbranch_scc1 L_pdone10
    s_sub_u32 s15, s15, 1
    s_cbranch_scc1 L_pdone10
    s_branch L_poll9
L_pdone10:
    v_perm_b32 v100, v101, v100, s65
    v_perm_b32 v101, v103, v102, s65
    ds_write_b64 v6, v[100:101] offset:3840
    ds_write_b32 v14, v14 offset:3508
    s_mov_b32 s15, 16000000
L_poll11:
    ds_read_b128 v[16:19], v14 offset:3568
    s_waitcnt lgkmcnt(0)
    v_or3_b32 v16, v16, v17, v18
    v_or_b32 v16, v16, v19
    v_cmp_eq_u32 vcc, 0, v16
    s_cmp_eq_u64 vcc, -1
    s_cbranch_scc1 L_pdone12
    s_sub_u32 s15, s15, 1
    s_cbranch_scc1 L_pdone12
    s_sleep 1
    s_branch L_poll11
L_pdone12:
    s_mov_b32 s15, 2000000
    buffer_load_dwordx4 v[48:51], v9, s[48:51], s13 offen sc1
    buffer_load_dwordx4 v[52:55], v9, s[48:51], s8 offen sc1
    s_sleep 2
L_pp13:
    buffer_load_dwordx4 v[56:59], v9, s[48:51], s13 offen sc1
    buffer_load_dwordx4 v[60:63], v9, s[48:51], s8 offen sc1
    s_waitcnt vmcnt(2)
    v_xor_b32 v48, s14, v48
    v_xor_b32 v49, s14, v49
    v_xor_b32 v50, s14, v50
    v_xor_b32 v51, s14, v51
    v_xor_b32 v52, s14, v52
    v_xor_b32 v53, s14, v53
    v_xor_b32 v54, s14, v54
    v_xor_b32 v55, s14, v55
    v_or3_b32 v12, v48, v49, v50
    v_or3_b32 v13, v51, v52, v53
    v_or3_b32 v12, v12, v54, v55
    v_or_b32 v12, v12, v13
    v_and_b32 v12, 255, v12
    v_cmp_eq_u32 vcc, 0, v12
    s_cmp_eq_u64 vcc, -1
    s_cbranch_scc1 L_ppg15
    buffer_load_dwordx4 v[48:51], v9, s[48:51], s13 offen sc1
    buffer_load_dwordx4 v[52:55], v9, s[48:51], s8 offen sc1
    s_waitcnt vmcnt(2)
    v_xor_b32 v56, s14, v56
    v_xor_b32 v57, s14, v57
    v_xor_b32 v58, s14, v58
    v_xor_b32 v59, s14, v59
    v_xor_b32 v60, s14, v60
    v_xor_b32 v61, s14, v61
    v_xor_b32 v62, s14, v62
    v_xor_b32 v63, s14, v63
    v_or3_b32 v12, v56, v57, v58
    v_or3_b32 v13, v59, v60, v61
    v_or3_b32 v12, v12, v62, v63
    v_or_b32 v12, v12, v13
    v_and_b32 v12, 255, v12
    v_cmp_eq_u32 vcc, 0, v12
    s_cmp_eq_u64 vcc, -1
    s_cbranch_scc1 L_ppg16
    s_sub_u32 s15, s15, 1
    s_cbranch_scc0 L_pp13
L_ppg15:
    v_mov_b32 v40, v48
    v_mov_b32 v41, v49
    v_mov_b32 v42, v50
    v_mov_b32 v43, v51
    v_mov_b32 v44, v52
    v_mov_b32 v45, v53
    v_mov_b32 v46, v54
    v_mov_b32 v47, v55
    s_branch L_ppo14
L_ppg16:
    v_mov_b32 v40, v56
    v_mov_b32 v41, v57
    v_mov_b32 v42, v58
    v_mov_b32 v43, v59
    v_mov_b32 v44, v60
    v_mov_b32 v45, v61
    v_mov_b32 v46, v62
    v_mov_b32 v47, v63
L_ppo14:
    v_add_f32 v40, v40, v44
    v_add_f32 v41, v41, v45
    v_add_f32 v42, v42, v46
    v_add_f32 v43, v43, v47
    v_lshlrev_b32 v36, 16, v36
    v_permlane32_swap_b32 v40, v42
    v_permlane32_swap_b32 v41, v43
    v_add_f32 v40, v40, v42
    v_add_f32 v41, v41, v43
    s_nop 1
    v_permlane16_swap_b32 v40, v41
    v_add_f32 v40, v40, v41
    s_nop 1
    v_add_f32_dpp v40, v40, v40 row_ror:8 row_mask:0xf bank_mask:0xf
    s_nop 1
    v_add_f32_dpp v40, v40, v40 row_ror:4 row_mask:0xf bank_mask:0xf
    s_nop 1
    v_add_f32_dpp v40, v40, v40 row_ror:2 row_mask:0xf bank_mask:0xf
    v_add_f32 v40, v40, v36
    v_cvt_pk_bf16_f32 v40, v40, v40
    s_mov_b32 exec_lo, 0x00030003
    s_mov_b32 exec_hi, 0x00030003
    buffer_store_short v40, v10, s[60:63], s12 offen
    s_cmp_lg_u32 s2, 0
    s_cbranch_scc1 L_S_END
    s_mov_b64 exec, 1
    s_mov_b32 s9, 0x70000
    buffer_store_dword v15, v14, s[48:51], s9 offen
L_S_END:
    s_endpgm
L_S123:
    v_mov_b32 v11, -1
    v_lshlrev_b32 v12, 2, v0
    ds_write_b32 v12, v11 offset:3200
    ds_write_b32 v12, v11 offset:3456
    s_waitcnt lgkmcnt(0)
    s_load_dword s14, s[38:39], 0x70000
    s_barrier
    s_mov_b32 s64, 0x05040100
    s_mov_b32 s65, 0x07060302
    s_mov_b32 s66, 0xffff0000
    s_mov_b32 s67, 0x3fb8aa3b
    s_mov_b32 s68, 0x3db504f3
    s_movk_i32 s69, 0xff
    s_mov_b32 s9, 14336
    s_add_u32 s5, s3, s98
    s_sub_u32 s4, s5, 7
    s_cmp_ge_u32 s5, 7
    s_cselect_b32 s5, s4, s5
    s_mul_i32 s6, s96, 7
    s_add_u32 s5, s5, s6
    s_add_u32 s6, s6, s98
    s_mov_b32 s61, s3
    v_mul_u32_u24 v10, 7168, v10
    v_lshl_add_u32 v10, v9, 4, v10
    s_mul_i32 s10, s7, 1835008
    s_lshl_b32 s11, s5, 7
    s_add_u32 s10, s10, s11
    s_lshl_b32 s4, s3, 2
    v_mov_b32 v13, s4
    s_mov_b32 s48, s38
    s_mov_b32 s49, s39
    s_mov_b32 s50, 0x4000000
    s_mov_b32 s51, 0x20000
    s_cmp_eq_u32 s61, 2
    s_cselect_b64 s[40:41], s[30:31], s[28:29]
    s_mov_b32 s42, 0x700000
    s_mov_b32 s43, 0x20000
    s_waitcnt lgkmcnt(0)
    s_add_u32 s14, s14, 1
    s_and_b32 s14, s14, 0xff
    v_mov_b32 v15, s14
    s_getpc_b64 s[12:13]
L_pcref:
    s_sub_u32 s12, s12, L_pcref - parallel_sum__gqa_block_cached__geglu_ffn__decode_kernel + 8192
    s_subb_u32 s13, s13, 0
    s_lshl_b32 s4, s97, 8
    v_lshl_add_u32 v1, v0, 7, s4
    v_lshl_add_u32 v1, v3, 13, v1
    s_mov_b64 exec, 3
    global_load_dword v2, v1, s[12:13]
    s_mov_b64 exec, -1
    s_cmp_eq_u32 s3, 3
    s_cbranch_scc1 L_S3
    ds_write_b32 v13, v14 offset:3508
    s_cmp_lt_u32 s98, 7
    s_cbranch_scc1 L_S12
    ds_write_b32 v13, v14 offset:3476
    s_cmp_eq_u32 s3, 1
    s_cbranch_scc1 L_S_END
    s_branch L_S2_h
L_S12:
    v_lshlrev_b32 v12, 1, v13
    s_mov_b32 s15, 16000000
L_poll17:
    ds_read_b32 v16, v14 offset:3492
    s_waitcnt lgkmcnt(0)
    v_cmp_eq_u32 vcc, 0, v16
    s_cmp_eq_u64 vcc, -1
    s_cbranch_scc1 L_pdone18
    s_sub_u32 s15, s15, 1
    s_cbranch_scc1 L_pdone18
    s_sleep 2
    s_branch L_poll17
L_pdone18:
    s_mov_b32 s15, 16000000
L_poll19:
    ds_read_b32 v16, v14 offset:3524
    s_waitcnt lgkmcnt(0)
    v_readfirstlane_b32 s101, v16
    s_cmp_lg_u32 s101, -1
    s_cbranch_scc1 L_pdone20
    s_sub_u32 s15, s15, 1
    s_cbranch_scc1 L_pdone20
    s_sleep 2
    s_branch L_poll19
L_pdone20:
    s_mov_b32 s15, 16000000
L_poll21:
    ds_read_b64 v[16:17], v12 offset:3544
    s_waitcnt lgkmcnt(0)
    v_or_b32 v16, v16, v17
    v_cmp_eq_u32 vcc, 0, v16
    s_cmp_eq_u64 vcc, -1
    s_cbranch_scc1 L_pdone22
    s_sub_u32 s15, s15, 1
    s_cbranch_scc1 L_pdone22
    s_sleep 2
    s_branch L_poll21
L_pdone22:
    buffer_load_dwordx4 v[72:75], v10, s[40:43], s10 offen nt
    s_add_u32 s10, s10, 7168
    buffer_load_dwordx4 v[76:79], v10, s[40:43], s10 offen nt
    s_add_u32 s10, s10, 7168
    buffer_load_dwordx4 v[80:83], v10, s[40:43], s10 offen nt
    s_add_u32 s10, s10, 7168
    buffer_load_dwordx4 v[84:87], v10, s[40:43], s10 offen nt
    s_add_u32 s10, s10, 7168
    buffer_load_dwordx4 v[88:91], v10, s[40:43], s10 offen nt
    s_add_u32 s10, s10, 7168
    buffer_load_dwordx4 v[92:95], v10, s[40:43], s10 offen nt
    s_add_u32 s10, s10, 7168
    buffer_load_dwordx4 v[96:99], v10, s[40:43], s10 offen nt
    s_add_u32 s10, s10, 7168
    buffer_load_dwordx4 v[100:103], v10, s[40:43], s10 offen nt
    s_add_u32 s10, s10, 408576
    buffer_load_dwordx4 v[104:107], v10, s[40:43], s10 offen nt
    s_add_u32 s10, s10, 7168
    buffer_load_dwordx4 v[108:111], v10, s[40:43], s10 offen nt
    s_add_u32 s10, s10, 7168
    buffer_load_dwordx4 v[112:115], v10, s[40:43], s10 offen nt
    s_add_u32 s10, s10, 7168
    buffer_load_dwordx4 v[116:119], v10, s[40:43], s10 offen nt
    s_add_u32 s10, s10, 7168
    s_waitcnt vmcnt(11)
    buffer_load_dwordx4 v[120:123], v10, s[40:43], s10 offen nt
    s_add_u32 s10, s10, 7168
    s_waitcnt vmcnt(11)
    buffer_load_dwordx4 v[124:127], v10, s[40:43], s10 offen nt
    s_add_u32 s10, s10, 7168
    s_waitcnt vmcnt(11)
    buffer_load_dwordx4 v[128:131], v10, s[40:43], s10 offen nt
    s_add_u32 s10, s10, 7168
    s_waitcnt vmcnt(11)
    buffer_load_dwordx4 v[132:135], v10, s[40:43], s10 offen nt
    s_add_u32 s10, s10, 408576
    s_waitcnt vmcnt(11)
    buffer_load_dwordx4 v[136:139], v10, s[40:43], s10 offen nt
    s_add_u32 s10, s10, 7168
    s_waitcnt vmcnt(11)
    buffer_load_dwordx4 v[140:143], v10, s[40:43], s10 offen nt
    s_add_u32 s10, s10, 7168
    s_waitcnt vmcnt(11)
    buffer_load_dwordx4 v[144:147], v10, s[40:43], s10 offen nt
    s_add_u32 s10, s10, 7168
    s_waitcnt vmcnt(11)
    buffer_load_dwordx4 v[148:151], v10, s[40:43], s10 offen nt
    s_add_u32 s10, s10, 7168
    s_waitcnt vmcnt(11)
    buffer_load_dwordx4 v[152:155], v10, s[40:43], s10 offen nt
    s_add_u32 s10, s10, 7168
    s_waitcnt vmcnt(11)
    buffer_load_dwordx4 v[156:159], v10, s[40:43], s10 offen nt
    s_add_u32 s10, s10, 7168
    s_waitcnt vmcnt(11)
    buffer_load_dwordx4 v[160:163], v10, s[40:43], s10 offen nt
    s_add_u32 s10, s10, 7168
    s_waitcnt vmcnt(11)
    buffer_load_dwordx4 v[164:167], v10, s[40:43], s10 offen nt
    s_add_u32 s10, s10, 408576
    s_waitcnt vmcnt(11)
    buffer_load_dwordx4 v[168:171], v10, s[40:43], s10 offen nt
    s_add_u32 s10, s10, 7168
    s_waitcnt vmcnt(11)
    buffer_load_dwordx4 v[172:175], v10, s[40:43], s10 offen nt
    s_add_u32 s10, s10, 7168
    s_waitcnt vmcnt(11)
    buffer_load_dwordx4 v[176:179], v10, s[40:43], s10 offen nt
    s_add_u32 s10, s10, 7168
    s_waitcnt vmcnt(11)
    buffer_load_dwordx4 v[180:183], v10, s[40:43], s10 offen nt
    s_add_u32 s10, s10, 7168
    s_waitcnt vmcnt(11)
    buffer_load_dwordx4 v[184:187], v10, s[40:43], s10 offen nt
    s_add_u32 s10, s10, 7168
    s_waitcnt vmcnt(11)
    buffer_load_dwordx4 v[188:191], v10, s[40:43], s10 offen nt
    s_add_u32 s10, s10, 7168
    s_waitcnt vmcnt(11)
    buffer_load_dwordx4 v[192:195], v10, s[40:43], s10 offen nt
    s_add_u32 s10, s10, 7168
    s_waitcnt vmcnt(11)
    buffer_load_dwordx4 v[196:199], v10, s[40:43], s10 offen nt
    ds_write_b32 v13, v14 offset:3476
    s_lshl1_add_u32 s10, s7, s61
    s_mul_i32 s10, s10, 28672
    s_lshl_b32 s12, s5, 8
    s_add_u32 s10, s10, s12
    s_add_u32 s10, s10, 102400
    s_mov_b32 s101, 0
    s_branch L_S_gemv
L_S2_h:
    s_and_b32 s62, s14, 63
    v_mov_b32 v15, 0
    v_lshlrev_b32 v6, 3, v0
    ds_write_b64 v6, v[14:15] offset:4352
    v_lshrrev_b32 v7, 5, v0
    v_and_b32 v6, 31, v0
    v_mul_u32_u24 v11, 14336, v7
    v_lshl_add_u32 v11, v6, 4, v11
    s_mul_i32 s10, s97, 448
    s_add_u32 s10, s10, 360448
    v_lshlrev_b32 v7, 8, v7
    v_lshl_add_u32 v60, v6, 2, 0
    v_mul_u32_u24 v12, 147, v60
    v_lshrrev_b32 v12, 10, v12
    v_add_u32 v60, v60, v12
    v_lshl_add_u32 v60, v60, 1, v7
    v_lshl_add_u32 v61, v6, 2, 1
    v_mul_u32_u24 v12, 147, v61
    v_lshrrev_b32 v12, 10, v12
    v_add_u32 v61, v61, v12
    v_lshl_add_u32 v61, v61, 1, v7
    v_lshl_add_u32 v62, v6, 2, 2
    v_mul_u32_u24 v12, 147, v62
    v_lshrrev_b32 v12, 10, v12
    v_add_u32 v62, v62, v12
    v_lshl_add_u32 v62, v62, 1, v7
    v_lshl_add_u32 v63, v6, 2, 3
    v_mul_u32_u24 v12, 147, v63
    v_lshrrev_b32 v12, 10, v12
    v_add_u32 v63, v63, v12
    v_lshl_add_u32 v63, v63, 1, v7
    s_mul_i32 s10, s97, 448
    s_add_u32 s10, s10, 131072
    s_add_u32 s17, s10, 28672
    s_add_u32 s18, s10, 57344
    s_add_u32 s19, s10, 86016
    s_add_u32 s20, s10, 114688
    s_add_u32 s21, s10, 143360
    s_add_u32 s22, s10, 172032
    s_add_u32 s23, s10, 200704
    s_mov_b32 s16, s10
    s_mov_b32 s4, 0x3d372713
    s_mov_b32 s5, 0xc0135761
    s_mov_b32 s15, 16000000
L_poll23:
    ds_read_b128 v[16:19], v14 offset:3584
    s_waitcnt lgkmcnt(0)
    v_or3_b32 v16, v16, v17, v18
    v_or_b32 v16, v16, v19
    v_cmp_eq_u32 vcc, 0, v16
    s_cmp_eq_u64 vcc, -1
    s_cbranch_scc1 L_pdone24
    s_sub_u32 s15, s15, 1
    s_cbranch_scc1 L_pdone24
    s_sleep 1
    s_branch L_poll23
L_pdone24:
    s_mov_b32 exec_lo, 0x0fffffff
    s_mov_b32 exec_hi, 0x0fffffff
    s_mov_b32 s15, 2000000
L_poll25:
    buffer_load_dwordx4 v[16:19], v11, s[48:51], s16 offen sc1
    buffer_load_dwordx4 v[20:23], v11, s[48:51], s17 offen sc1
    buffer_load_dwordx4 v[24:27], v11, s[48:51], s18 offen sc1
    buffer_load_dwordx4 v[28:31], v11, s[48:51], s19 offen sc1
    buffer_load_dwordx4 v[32:35], v11, s[48:51], s20 offen sc1
    buffer_load_dwordx4 v[36:39], v11, s[48:51], s21 offen sc1
    buffer_load_dwordx4 v[40:43], v11, s[48:51], s22 offen sc1
    buffer_load_dwordx4 v[44:47], v11, s[48:51], s23 offen sc1
    s_waitcnt vmcnt(0)
    v_xor_b32 v16, s62, v16
    v_xor_b32 v17, s62, v17
    v_xor_b32 v18, s62, v18
    v_xor_b32 v19, s62, v19
    v_xor_b32 v20, s62, v20
    v_xor_b32 v21, s62, v21
    v_xor_b32 v22, s62, v22
    v_xor_b32 v23, s62, v23
    v_xor_b32 v24, s62, v24
    v_xor_b32 v25, s62, v25
    v_xor_b32 v26, s62, v26
    v_xor_b32 v27, s62, v27
    v_xor_b32 v28, s62, v28
    v_xor_b32 v29, s62, v29
    v_xor_b32 v30, s62, v30
    v_xor_b32 v31, s62, v31
    v_xor_b32 v32, s62, v32
    v_xor_b32 v33, s62, v33
    v_xor_b32 v34, s62, v34
    v_xor_b32 v35, s62, v35
    v_xor_b32 v36, s62, v36
    v_xor_b32 v37, s62, v37
    v_xor_b32 v38, s62, v38
    v_xor_b32 v39, s62, v39
    v_xor_b32 v40, s62, v40
    v_xor_b32 v41, s62, v41
    v_xor_b32 v42, s62, v42
    v_xor_b32 v43, s62, v43
    v_xor_b32 v44, s62, v44
    v_xor_b32 v45, s62, v45
    v_xor_b32 v46, s62, v46
    v_xor_b32 v47, s62, v47
    v_or3_b32 v12, v16, v17, v18
    v_or3_b32 v13, v19, v20, v21
    v_or3_b32 v12, v12, v22, v23
    v_or3_b32 v13, v13, v24, v25
    v_or3_b32 v12, v12, v26, v27
    v_or3_b32 v13, v13, v28, v29
    v_or3_b32 v12, v12, v30, v31
    v_or3_b32 v13, v13, v32, v33
    v_or3_b32 v12, v12, v34, v35
    v_or3_b32 v13, v13, v36, v37
    v_or3_b32 v12, v12, v38, v39
    v_or3_b32 v13, v13, v40, v41
    v_or3_b32 v12, v12, v42, v43
    v_or3_b32 v13, v13, v44, v45
    v_or3_b32 v12, v12, v46, v47
    v_or_b32 v12, v12, v13
    v_and_b32 v12, 63, v12
    v_cmp_eq_u32 vcc, 0, v12
    s_cmp_eq_u64 vcc, exec
    s_cbranch_scc1 L_pdone26
    s_sub_u32 s15, s15, 1
    s_cbranch_scc1 L_pdone26
    s_branch L_poll25
L_pdone26:
    v_add_f32 v16, v16, v24
    v_add_f32 v32, v32, v40
    v_add_f32 v17, v17, v25
    v_add_f32 v33, v33, v41
    v_add_f32 v18, v18, v26
    v_add_f32 v34, v34, v42
    v_add_f32 v19, v19, v27
    v_add_f32 v35, v35, v43
    v_add_f32 v20, v20, v28
    v_add_f32 v36, v36, v44
    v_add_f32 v21, v21, v29
    v_add_f32 v37, v37, v45
    v_add_f32 v22, v22, v30
    v_add_f32 v38, v38, v46
    v_add_f32 v23, v23, v31
    v_add_f32 v39, v39, v47
    v_add_f32 v16, v16, v32
    v_add_f32 v17, v17, v33
    v_add_f32 v18, v18, v34
    v_add_f32 v19, v19, v35
    v_add_f32 v20, v20, v36
    v_add_f32 v21, v21, v37
    v_add_f32 v22, v22, v38
    v_add_f32 v23, v23, v39
    v_cvt_pk_bf16_f32 v16, v16, v16
    v_lshlrev_b32 v16, 16, v16
    v_cvt_pk_bf16_f32 v17, v17, v17
    v_lshlrev_b32 v17, 16, v17
    v_cvt_pk_bf16_f32 v18, v18, v18
    v_lshlrev_b32 v18, 16, v18
    v_cvt_pk_bf16_f32 v19, v19, v19
    v_lshlrev_b32 v19, 16, v19
    v_cvt_pk_bf16_f32 v20, v20, v20
    v_lshlrev_b32 v20, 16, v20
    v_cvt_pk_bf16_f32 v21, v21, v21
    v_lshlrev_b32 v21, 16, v21
    v_cvt_pk_bf16_f32 v22, v22, v22
    v_lshlrev_b32 v22, 16, v22
    v_cvt_pk_bf16_f32 v23, v23, v23
    v_lshlrev_b32 v23, 16, v23
    v_mul_f32 v24, v16, v16
    v_mul_f32 v25, v17, v17
    v_mul_f32 v26, v18, v18
    v_mul_f32 v27, v19, v19
    v_mul_f32 v24, v24, v16
    v_mul_f32 v25, v25, v17
    v_mul_f32 v26, v26, v18
    v_mul_f32 v27, v27, v19
    v_fma_f32 v24, v24, s4, v16
    v_fma_f32 v25, v25, s4, v17
    v_fma_f32 v26, v26, s4, v18
    v_fma_f32 v27, v27, s4, v19
    v_mul_f32 v24, s5, v24
    v_mul_f32 v25, s5, v25
    v_mul_f32 v26, s5, v26
    v_mul_f32 v27, s5, v27
    v_exp_f32 v24, v24
    v_exp_f32 v25, v25
    v_exp_f32 v26, v26
    v_exp_f32 v27, v27
    v_add_f32 v24, 1.0, v24
    v_add_f32 v25, 1.0, v25
    v_add_f32 v26, 1.0, v26
    v_add_f32 v27, 1.0, v27
    v_rcp_f32 v24, v24
    v_rcp_f32 v25, v25
    v_rcp_f32 v26, v26
    v_rcp_f32 v27, v27
    v_mul_f32 v24, v24, v16
    v_mul_f32 v25, v25, v17
    v_mul_f32 v26, v26, v18
    v_mul_f32 v27, v27, v19
    v_cvt_pk_bf16_f32 v24, v24, v24
    v_lshlrev_b32 v24, 16, v24
    v_cvt_pk_bf16_f32 v25, v25, v25
    v_lshlrev_b32 v25, 16, v25
    v_cvt_pk_bf16_f32 v26, v26, v26
    v_lshlrev_b32 v26, 16, v26
    v_cvt_pk_bf16_f32 v27, v27, v27
    v_lshlrev_b32 v27, 16, v27
    v_mul_f32 v24, v24, v20
    v_mul_f32 v25, v25, v21
    v_mul_f32 v26, v26, v22
    v_mul_f32 v27, v27, v23
    v_cvt_pk_bf16_f32 v16, v24, v24
    v_cvt_pk_bf16_f32 v17, v25, v25
    v_cvt_pk_bf16_f32 v18, v26, v26
    v_cvt_pk_bf16_f32 v19, v27, v27
    ds_write_b16_d16_hi v60, v16 offset:4352
    ds_write_b16_d16_hi v61, v17 offset:4352
    ds_write_b16_d16_hi v62, v18 offset:4352
    ds_write_b16_d16_hi v63, v19 offset:4352
    ds_write_b32 v14, v14 offset:3504
    s_branch L_S_END
L_S3:
    ds_write_b32 v14, v14 offset:3520
    s_getreg_b32 s4, hwreg(HW_REG_XCC_ID)
    s_and_b32 s4, s4, 15
    s_lshl_b32 s4, s4, 8
    s_or_b32 s5, s14, 0x5a3c6000
    s_or_b32 s4, s4, s5
    v_mov_b32 v16, s4
    s_lshl_b32 s10, s99, 2
    s_add_u32 s10, s10, 425984
    s_mov_b64 exec, 1
    buffer_store_dword v16, v14, s[48:51], s10 offen
    s_mov_b64 exec, -1
    v_and_b32 v7, 31, v0
    v_lshlrev_b32 v7, 2, v7
    s_lshl_b32 s10, s96, 7
    s_add_u32 s10, s10, 425984
    s_mov_b32 s15, 16000000
L_poll27:
    ds_read_b64 v[16:17], v14 offset:3512
    ds_read_b32 v18, v14 offset:3488
    s_waitcnt lgkmcnt(0)
    v_or3_b32 v16, v16, v17, v18
    v_cmp_eq_u32 vcc, 0, v16
    s_cmp_eq_u64 vcc, -1
    s_cbranch_scc1 L_pdone28
    s_sub_u32 s15, s15, 1
    s_cbranch_scc1 L_pdone28
    s_sleep 2
    s_branch L_poll27
L_pdone28:
    buffer_load_dword v16, v7, s[48:51], s10 offen sc1
    s_waitcnt vmcnt(0)
    v_cmp_eq_u32 vcc, s4, v16
    s_cmp_eq_u64 vcc, -1
    s_cselect_b32 s101, 1, 0
    v_mov_b32 v16, s101
    ds_write_b32 v14, v16 offset:3524
    v_and_b32 v6, 7, v0
    v_lshlrev_b32 v6, 3, v6
    v_and_b32 v7, 31, v0
    v_lshlrev_b32 v7, 3, v7
    s_lshl_b32 s13, s99, 6
    s_add_u32 s13, s13, 393216
    s_mov_b32 s15, 16000000
L_poll29:
    ds_read_b64 v[16:17], v6 offset:3200
    ds_read_b64 v[18:19], v6 offset:3264
    ds_read_b64 v[20:21], v6 offset:3328
    ds_read_b64 v[22:23], v6 offset:3392
    s_waitcnt lgkmcnt(0)
    v_max3_u32 v11, v16, v17, v18
    v_max3_u32 v11, v11, v19, v20
    v_max3_u32 v11, v11, v21, v22
    v_max_u32 v11, v11, v23
    v_cmp_ne_u32 vcc, -1, v11
    s_cmp_eq_u64 vcc, -1
    s_cbranch_scc1 L_pdone30
    s_sub_u32 s15, s15, 1
    s_cbranch_scc1 L_pdone30
    s_sleep 2
    s_branch L_poll29
L_pdone30:
    ds_read_b32 v30, v7 offset:3200
    v_max3_f32 v24, v16, v18, v20
    v_max_f32 v24, v24, v22
    v_sub_f32 v16, v16, v24
    v_sub_f32 v18, v18, v24
    v_sub_f32 v20, v20, v24
    v_sub_f32 v22, v22, v24
    v_mul_f32 v16, s67, v16
    v_mul_f32 v18, s67, v18
    v_mul_f32 v20, s67, v20
    v_mul_f32 v22, s67, v22
    v_exp_f32 v16, v16
    v_exp_f32 v18, v18
    v_exp_f32 v20, v20
    v_exp_f32 v22, v22
    s_nop 0
    v_mul_f32 v25, v16, v17
    v_fmac_f32 v25, v18, v19
    v_fmac_f32 v25, v20, v21
    v_fmac_f32 v25, v22, v23
    v_bfi_b32 v24, s69, v15, v24
    v_bfi_b32 v25, s69, v15, v25
    s_mov_b64 exec, 0xff
    s_cmp_eq_u32 s101, 1
    s_cbranch_scc1 L_stf31
    buffer_store_dwordx2 v[24:25], v6, s[48:51], s13 offen sc1
    s_branch L_std32
L_stf31:
    buffer_store_dwordx2 v[24:25], v6, s[48:51], s13 offen
L_std32:
    s_mov_b64 exec, -1
    s_lshl_b32 s10, s96, 11
    s_add_u32 s10, s10, 393216
    v_lshlrev_b32 v7, 3, v0
    buffer_load_dword v16, v7, s[48:51], s10 offen offset:0 sc1
    buffer_load_dword v17, v7, s[48:51], s10 offen offset:512 sc1
    buffer_load_dword v18, v7, s[48:51], s10 offen offset:1024 sc1
    buffer_load_dword v19, v7, s[48:51], s10 offen offset:1536 sc1
    s_waitcnt vmcnt(0)
    s_mov_b32 s4, 0
    v_and_b32 v16, 0xffff, v16
    v_cmp_eq_u32 vcc, s14, v16
    s_bcnt1_i32_b64 s5, vcc
    s_add_u32 s4, s4, s5
    v_and_b32 v17, 0xffff, v17
    v_cmp_eq_u32 vcc, s14, v17
    s_bcnt1_i32_b64 s5, vcc
    s_add_u32 s4, s4, s5
    v_and_b32 v18, 0xffff, v18
    v_cmp_eq_u32 vcc, s14, v18
    s_bcnt1_i32_b64 s5, vcc
    s_add_u32 s4, s4, s5
    v_and_b32 v19, 0xffff, v19
    v_cmp_eq_u32 vcc, s14, v19
    s_bcnt1_i32_b64 s5, vcc
    s_add_u32 s4, s4, s5
    s_cmp_ge_u32 s4, 176
    s_cselect_b32 s5, 1, 0
    s_cmp_ge_u32 s4, 224
    s_cselect_b32 s5, 3, s5
    v_mov_b32 v16, s5
    ds_write_b32 v14, v16 offset:3520
    s_mov_b32 s15, 16000000
L_poll33:
    ds_read_b32 v16, v14 offset:3476
    s_waitcnt lgkmcnt(0)
    v_cmp_eq_u32 vcc, 0, v16
    s_cmp_eq_u64 vcc, -1
    s_cbranch_scc1 L_pdone34
    s_sub_u32 s15, s15, 1
    s_cbranch_scc1 L_pdone34
    s_sleep 2
    s_branch L_poll33
L_pdone34:
    s_mov_b32 s15, 2000000
L_poll35:
    buffer_load_dwordx2 v[16:17], v7, s[48:51], s10 offen offset:0 sc1
    buffer_load_dwordx2 v[18:19], v7, s[48:51], s10 offen offset:512 sc1
    buffer_load_dwordx2 v[20:21], v7, s[48:51], s10 offen offset:1024 sc1
    buffer_load_dwordx2 v[22:23], v7, s[48:51], s10 offen offset:1536 sc1
    s_waitcnt vmcnt(0)
    v_xor_b32 v16, s14, v16
    v_xor_b32 v17, s14, v17
    v_xor_b32 v18, s14, v18
    v_xor_b32 v19, s14, v19
    v_xor_b32 v20, s14, v20
    v_xor_b32 v21, s14, v21
    v_xor_b32 v22, s14, v22
    v_xor_b32 v23, s14, v23
    v_or3_b32 v11, v16, v17, v18
    v_or3_b32 v12, v19, v20, v21
    v_or3_b32 v11, v11, v22, v23
    v_or_b32 v11, v11, v12
    v_and_b32 v11, 255, v11
    v_cmp_eq_u32 vcc, 0, v11
    s_cmp_eq_u64 vcc, -1
    s_cbranch_scc1 L_pdone36
    s_sub_u32 s15, s15, 1
    s_cbranch_scc1 L_pdone36
    s_sleep 8
    s_branch L_poll35
L_pdone36:
    v_max3_f32 v26, v16, v18, v20
    v_max_f32 v26, v26, v22
    s_nop 1
    v_max_f32_dpp v26, v26, v26 row_ror:8 row_mask:0xf bank_mask:0xf
    v_mov_b32 v11, v26
    s_nop 1
    v_permlane16_swap_b32 v26, v11
    v_max_f32 v26, v26, v11
    v_mov_b32 v11, v26
    s_nop 1
    v_permlane32_swap_b32 v26, v11
    v_max_f32 v26, v26, v11
    v_sub_f32 v16, v16, v26
    v_sub_f32 v18, v18, v26
    v_sub_f32 v20, v20, v26
    v_sub_f32 v22, v22, v26
    v_mul_f32 v16, s67, v16
    v_mul_f32 v18, s67, v18
    v_mul_f32 v20, s67, v20
    v_mul_f32 v22, s67, v22
    v_exp_f32 v16, v16
    v_exp_f32 v18, v18
    v_exp_f32 v20, v20
    v_exp_f32 v22, v22
    s_nop 0
    v_mul_f32 v27, v16, v17
    v_fmac_f32 v27, v18, v19
    v_fmac_f32 v27, v20, v21
    v_fmac_f32 v27, v22, v23
    s_nop 1
    v_add_f32_dpp v27, v27, v27 row_ror:8 row_mask:0xf bank_mask:0xf
    v_mov_b32 v11, v27
    s_nop 1
    v_permlane16_swap_b32 v27, v11
    v_add_f32 v27, v27, v11
    v_mov_b32 v11, v27
    s_nop 1
    v_permlane32_swap_b32 v27, v11
    v_add_f32 v27, v27, v11
    v_sub_f32 v30, v30, v26
    v_mul_f32 v30, s67, v30
    v_exp_f32 v30, v30
    v_rcp_f32 v27, v27
    v_bfe_u32 v7, v0, 3, 2
    v_lshlrev_b32 v7, 2, v7
    v_lshl_add_u32 v7, v6, 1, v7
    v_mul_f32 v30, v30, v27
    ds_write_b32 v7, v30 offset:3712
    ds_write_b32 v14, v14 offset:3472
    v_lshlrev_b32 v6, 4, v9
    v_lshl_add_u32 v6, v5, 2, v6
    v_lshlrev_b32 v7, 4, v0
    s_lshl_b32 s10, s99, 12
    s_add_u32 s10, s10, 524288
    s_lshl_b32 s8, s99, 7
    s_add_u32 s8, s8, 491520
    s_mov_b32 s15, 16000000
L_poll37:
    ds_read_b128 v[16:19], v14 offset:3456
    s_waitcnt lgkmcnt(0)
    v_or3_b32 v16, v16, v17, v18
    v_or_b32 v16, v16, v19
    v_cmp_eq_u32 vcc, 0, v16
    s_cmp_eq_u64 vcc, -1
    s_cbranch_scc1 L_pdone38
    s_sub_u32 s15, s15, 1
    s_cbranch_scc1 L_pdone38
    s_sleep 2
    s_branch L_poll37
L_pdone38:
    s_mov_b32 s15, 2000000
L_poll39:
    buffer_load_dwordx4 v[40:43], v7, s[48:51], s10 offen offset:0 sc1
    buffer_load_dwordx4 v[44:47], v7, s[48:51], s10 offen offset:1024 sc1
    buffer_load_dwordx4 v[48:51], v7, s[48:51], s10 offen offset:2048 sc1
    buffer_load_dwordx4 v[52:55], v7, s[48:51], s10 offen offset:3072 sc1
    s_waitcnt vmcnt(0)
    v_xor_b32 v40, s14, v40
    v_xor_b32 v41, s14, v41
    v_xor_b32 v42, s14, v42
    v_xor_b32 v43, s14, v43
    v_xor_b32 v44, s14, v44
    v_xor_b32 v45, s14, v45
    v_xor_b32 v46, s14, v46
    v_xor_b32 v47, s14, v47
    v_xor_b32 v48, s14, v48
    v_xor_b32 v49, s14, v49
    v_xor_b32 v50, s14, v50
    v_xor_b32 v51, s14, v51
    v_xor_b32 v52, s14, v52
    v_xor_b32 v53, s14, v53
    v_xor_b32 v54, s14, v54
    v_xor_b32 v55, s14, v55
    v_or3_b32 v12, v40, v41, v42
    v_or3_b32 v13, v43, v44, v45
    v_or3_b32 v12, v12, v46, v47
    v_or3_b32 v13, v13, v48, v49
    v_or3_b32 v12, v12, v50, v51
    v_or3_b32 v13, v13, v52, v53
    v_or3_b32 v12, v12, v54, v55
    v_or_b32 v12, v12, v13
    v_and_b32 v12, 255, v12
    v_cmp_eq_u32 vcc, 0, v12
    s_cmp_eq_u64 vcc, -1
    s_cbranch_scc1 L_pdone40
    s_sub_u32 s15, s15, 1
    s_cbranch_scc1 L_pdone40
    s_branch L_poll39
L_pdone40:
    v_add_f32 v40, v40, v44
    v_add_f32 v48, v48, v52
    v_add_f32 v41, v41, v45
    v_add_f32 v49, v49, v53
    v_add_f32 v42, v42, v46
    v_add_f32 v50, v50, v54
    v_add_f32 v43, v43, v47
    v_add_f32 v51, v51, v55
    v_add_f32 v40, v40, v48
    v_add_f32 v41, v41, v49
    v_add_f32 v42, v42, v50
    v_add_f32 v43, v43, v51
    s_nop 0
    v_permlane32_swap_b32 v40, v42
    v_permlane32_swap_b32 v41, v43
    v_add_f32 v40, v40, v42
    v_add_f32 v41, v41, v43
    s_nop 1
    v_permlane16_swap_b32 v40, v41
    v_add_f32 v40, v40, v41
    s_nop 1
    v_add_f32_dpp v40, v40, v40 row_ror:8 row_mask:0xf bank_mask:0xf
    v_cvt_pk_bf16_f32 v40, v40, v40
    v_bfi_b32 v40, s69, v15, v40
    s_mov_b32 exec_lo, 0x00ff00ff
    s_mov_b32 exec_hi, 0x00ff00ff
    buffer_store_dword v40, v6, s[48:51], s8 offen sc1
    s_branch L_S_END
L_ATT2:
    s_load_dword s14, s[38:39], 0x70000
    v_lshlrev_b32 v7, 4, v0
    s_lshl_b32 s9, s6, 2
    v_mov_b32 v13, s9
    s_mov_b32 s44, s20
    s_mov_b32 s45, s21
    s_mov_b32 s46, 0x4000000
    s_mov_b32 s47, 0x20000
    s_mov_b32 s48, s38
    s_mov_b32 s49, s39
    s_mov_b32 s50, 0x4000000
    s_mov_b32 s51, 0x20000
    s_mov_b32 s52, s24
    s_mov_b32 s53, s25
    s_mov_b32 s54, 0x800000
    s_mov_b32 s55, 0x20000
    s_mov_b32 s56, s32
    s_mov_b32 s57, s33
    s_mov_b32 s58, 0x700000
    s_mov_b32 s59, 0x20000
    s_mov_b32 s64, 0x05040100
    s_mov_b32 s65, 0x07060302
    s_mov_b32 s66, 0xffff0000
    s_mov_b32 s67, 0x3fb8aa3b
    s_mov_b32 s68, 0x3db504f3
    s_movk_i32 s69, 0xff
    v_mul_u32_u24 v11, 272, v9
    v_lshl_add_u32 v11, v5, 5, v11
    v_lshl_add_u32 v11, v8, 4, v11
    v_mov_b32 v10, 0xff800000
    buffer_load_dwordx4 v[24:27], v6, s[40:43], s7 offen offset:2048 nt
    s_barrier
    buffer_load_dwordx4 v[28:31], v6, s[40:43], s7 offen offset:2176 nt
    s_add_u32 s7, s7, 16384
    buffer_load_dwordx4 v[32:35], v6, s[40:43], s7 offen offset:0 nt
    buffer_load_dwordx4 v[36:39], v6, s[40:43], s7 offen offset:128 nt
    s_waitcnt vmcnt(5)
    buffer_load_dwordx4 v[40:43], v6, s[40:43], s7 offen offset:2048 nt
    s_waitcnt vmcnt(5)
    buffer_load_dwordx4 v[44:47], v6, s[40:43], s7 offen offset:2176 nt
    s_add_u32 s7, s7, 16384
    s_waitcnt vmcnt(5)
    buffer_load_dwordx4 v[48:51], v6, s[40:43], s7 offen offset:0 nt
    s_waitcnt vmcnt(5)
    buffer_load_dwordx4 v[52:55], v6, s[40:43], s7 offen offset:128 nt
    s_waitcnt vmcnt(5)
    buffer_load_dwordx4 v[56:59], v6, s[40:43], s7 offen offset:2048 nt
    s_waitcnt vmcnt(5)
    buffer_load_dwordx4 v[60:63], v6, s[40:43], s7 offen offset:2176 nt
    s_add_u32 s7, s7, 16384
    s_waitcnt vmcnt(5)
    buffer_load_dwordx4 v[64:67], v6, s[40:43], s7 offen offset:0 nt
    s_waitcnt vmcnt(5)
    buffer_load_dwordx4 v[68:71], v6, s[40:43], s7 offen offset:128 nt
    s_waitcnt vmcnt(5)
    buffer_load_dwordx4 v[72:75], v6, s[40:43], s7 offen offset:2048 nt
    s_waitcnt vmcnt(5)
    buffer_load_dwordx4 v[76:79], v6, s[40:43], s7 offen offset:2176 nt
    s_add_u32 s7, s7, 16384
    s_waitcnt vmcnt(5)
    buffer_load_dwordx4 v[80:83], v6, s[40:43], s7 offen offset:0 nt
    s_waitcnt vmcnt(5)
    buffer_load_dwordx4 v[84:87], v6, s[40:43], s7 offen offset:128 nt
    s_waitcnt vmcnt(5)
    buffer_load_dwordx4 v[88:91], v6, s[40:43], s7 offen offset:2048 nt
    s_waitcnt vmcnt(5)
    buffer_load_dwordx4 v[92:95], v6, s[40:43], s7 offen offset:2176 nt
    s_add_u32 s7, s7, 16384
    s_waitcnt vmcnt(5)
    buffer_load_dwordx4 v[96:99], v6, s[40:43], s7 offen offset:0 nt
    s_waitcnt vmcnt(5)
    buffer_load_dwordx4 v[100:103], v6, s[40:43], s7 offen offset:128 nt
    s_waitcnt vmcnt(5)
    buffer_load_dwordx4 v[104:107], v6, s[40:43], s7 offen offset:2048 nt
    s_waitcnt vmcnt(5)
    buffer_load_dwordx4 v[108:111], v6, s[40:43], s7 offen offset:2176 nt
    s_add_u32 s7, s7, 16384
    ds_write_b32 v14, v14 offset:3496
    s_waitcnt vmcnt(5)
    buffer_load_dwordx4 v[112:115], v6, s[40:43], s7 offen offset:0 nt
    s_waitcnt vmcnt(5)
    buffer_load_dwordx4 v[116:119], v6, s[40:43], s7 offen offset:128 nt
    s_waitcnt vmcnt(5)
    buffer_load_dwordx4 v[120:123], v6, s[40:43], s7 offen offset:2048 nt
    s_waitcnt vmcnt(5)
    buffer_load_dwordx4 v[124:127], v6, s[40:43], s7 offen offset:2176 nt
    s_add_u32 s7, s7, 16384
    s_waitcnt vmcnt(5)
    buffer_load_dwordx4 v[128:131], v6, s[40:43], s7 offen offset:0 nt
    s_waitcnt vmcnt(5)
    buffer_load_dwordx4 v[132:135], v6, s[40:43], s7 offen offset:128 nt
    s_waitcnt vmcnt(5)
    buffer_load_dwordx4 v[136:139], v6, s[40:43], s7 offen offset:2048 nt
    s_waitcnt vmcnt(5)
    buffer_load_dwordx4 v[140:143], v6, s[40:43], s7 offen offset:2176 nt
    s_add_u32 s7, s7, 16384
    s_waitcnt vmcnt(5)
    buffer_load_dwordx4 v[144:147], v6, s[40:43], s7 offen offset:0 nt
    s_waitcnt vmcnt(5)
    buffer_load_dwordx4 v[148:151], v6, s[40:43], s7 offen offset:128 nt
    s_waitcnt vmcnt(5)
    buffer_load_dwordx4 v[152:155], v6, s[40:43], s7 offen offset:2048 nt
    s_waitcnt vmcnt(5)
    buffer_load_dwordx4 v[156:159], v6, s[40:43], s7 offen offset:2176 nt
    s_add_u32 s7, s7, 16384
    s_waitcnt vmcnt(5)
    buffer_load_dwordx4 v[160:163], v6, s[40:43], s7 offen offset:0 nt
    s_waitcnt vmcnt(5)
    buffer_load_dwordx4 v[164:167], v6, s[40:43], s7 offen offset:128 nt
    s_waitcnt vmcnt(5)
    buffer_load_dwordx4 v[168:171], v6, s[40:43], s7 offen offset:2048 nt
    s_waitcnt vmcnt(5)
    buffer_load_dwordx4 v[172:175], v6, s[40:43], s7 offen offset:2176 nt
    s_add_u32 s7, s7, 16384
    s_mov_b32 s15, 16000000
L_poll41:
    ds_read_b32 v208, v14 offset:3488
    s_waitcnt lgkmcnt(0)
    v_cmp_eq_u32 vcc, 0, v208
    s_cmp_eq_u64 vcc, -1
    s_cbranch_scc1 L_pdone42
    s_sub_u32 s15, s15, 1
    s_cbranch_scc1 L_pdone42
    s_sleep 1
    s_branch L_poll41
L_pdone42:
    s_add_u32 s14, s14, 1
    s_and_b32 s14, s14, 0xff
    v_mov_b32 v15, s14
    ds_read_b128 v[208:211], v11 offset:1024
    ds_read_b128 v[212:215], v11 offset:1152
    s_waitcnt lgkmcnt(0)
    s_waitcnt vmcnt(36)
    v_mfma_f32_16x16x32_bf16 v[216:219], v[16:19], v[208:211], 0
    v_mfma_f32_16x16x32_bf16 v[216:219], v[20:23], v[212:215], v[216:219]
    v_mfma_f32_16x16x32_bf16 v[220:223], v[24:27], v[208:211], 0
    v_mfma_f32_16x16x32_bf16 v[220:223], v[28:31], v[212:215], v[220:223]
    s_waitcnt vmcnt(5)
    buffer_load_dwordx4 v[16:19], v6, s[40:43], s7 offen offset:0 nt
    s_waitcnt vmcnt(5)
    buffer_load_dwordx4 v[20:23], v6, s[40:43], s7 offen offset:128 nt
    s_waitcnt vmcnt(5)
    buffer_load_dwordx4 v[24:27], v6, s[40:43], s7 offen offset:2048 nt
    s_waitcnt vmcnt(5)
    buffer_load_dwordx4 v[28:31], v6, s[40:43], s7 offen offset:2176 nt
    s_add_u32 s7, s7, 16384
    s_waitcnt vmcnt(36)
    v_mfma_f32_16x16x32_bf16 v[224:227], v[32:35], v[208:211], 0
    v_mfma_f32_16x16x32_bf16 v[224:227], v[36:39], v[212:215], v[224:227]
    v_mfma_f32_16x16x32_bf16 v[228:231], v[40:43], v[208:211], 0
    v_mfma_f32_16x16x32_bf16 v[228:231], v[44:47], v[212:215], v[228:231]
    s_waitcnt vmcnt(5)
    buffer_load_dwordx4 v[32:35], v6, s[40:43], s7 offen offset:0 nt
    s_nop 3
    v_add_f32_dpp v238, v217, v216 row_ror:8 row_mask:0xf bank_mask:0xf
    v_add_f32_dpp v239, v219, v218 row_ror:8 row_mask:0xf bank_mask:0xf
    v_add_f32_dpp v240, v221, v220 row_ror:8 row_mask:0xf bank_mask:0xf
    v_add_f32_dpp v241, v223, v222 row_ror:8 row_mask:0xf bank_mask:0xf
    v_max3_f32 v10, v10, v238, v239
    v_cvt_pk_bf16_f32 v236, v238, v239
    v_cvt_pk_bf16_f32 v237, v240, v241
    v_max3_f32 v10, v10, v240, v241
    v_lshlrev_b32 v232, 16, v236
    v_and_b32 v233, s66, v236
    v_lshlrev_b32 v234, 16, v237
    v_and_b32 v235, s66, v237
    v_mul_f32 v232, s68, v232
    v_mul_f32 v233, s68, v233
    v_mul_f32 v234, s68, v234
    v_mul_f32 v235, s68, v235
    v_cvt_pk_bf16_f32 v176, v232, v233
    v_cvt_pk_bf16_f32 v177, v234, v235
    s_waitcnt vmcnt(33)
    v_mfma_f32_16x16x32_bf16 v[216:219], v[48:51], v[208:211], 0
    v_mfma_f32_16x16x32_bf16 v[216:219], v[52:55], v[212:215], v[216:219]
    v_mfma_f32_16x16x32_bf16 v[220:223], v[56:59], v[208:211], 0
    v_mfma_f32_16x16x32_bf16 v[220:223], v[60:63], v[212:215], v[220:223]
    s_waitcnt vmcnt(5)
    buffer_load_dwordx4 v[36:39], v6, s[40:43], s7 offen offset:128 nt
    s_nop 3
    v_add_f32_dpp v238, v225, v224 row_ror:8 row_mask:0xf bank_mask:0xf
    v_add_f32_dpp v239, v227, v226 row_ror:8 row_mask:0xf bank_mask:0xf
    v_add_f32_dpp v240, v229, v228 row_ror:8 row_mask:0xf bank_mask:0xf
    v_add_f32_dpp v241, v231, v230 row_ror:8 row_mask:0xf bank_mask:0xf
    v_max3_f32 v10, v10, v238, v239
    v_cvt_pk_bf16_f32 v236, v238, v239
    v_cvt_pk_bf16_f32 v237, v240, v241
    v_max3_f32 v10, v10, v240, v241
    v_lshlrev_b32 v232, 16, v236
    v_and_b32 v233, s66, v236
    v_lshlrev_b32 v234, 16, v237
    v_and_b32 v235, s66, v237
    v_mul_f32 v232, s68, v232
    v_mul_f32 v233, s68, v233
    v_mul_f32 v234, s68, v234
    v_mul_f32 v235, s68, v235
    v_cvt_pk_bf16_f32 v178, v232, v233
    v_cvt_pk_bf16_f32 v179, v234, v235
    s_waitcnt vmcnt(30)
    v_mfma_f32_16x16x32_bf16 v[224:227], v[64:67], v[208:211], 0
    v_mfma_f32_16x16x32_bf16 v[224:227], v[68:71], v[212:215], v[224:227]
    v_mfma_f32_16x16x32_bf16 v[228:231], v[72:75], v[208:211], 0
    v_mfma_f32_16x16x32_bf16 v[228:231], v[76:79], v[212:215], v[228:231]
    s_waitcnt vmcnt(5)
    buffer_load_dwordx4 v[40:43], v6, s[40:43], s7 offen offset:2048 nt
    s_nop 3
    v_add_f32_dpp v238, v217, v216 row_ror:8 row_mask:0xf bank_mask:0xf
    v_add_f32_dpp v239, v219, v218 row_ror:8 row_mask:0xf bank_mask:0xf
    v_add_f32_dpp v240, v221, v220 row_ror:8 row_mask:0xf bank_mask:0xf
    v_add_f32_dpp v241, v223, v222 row_ror:8 row_mask:0xf bank_mask:0xf
    v_max3_f32 v10, v10, v238, v239
    v_cvt_pk_bf16_f32 v236, v238, v239
    v_cvt_pk_bf16_f32 v237, v240, v241
    v_max3_f32 v10, v10, v240, v241
    v_lshlrev_b32 v232, 16, v236
    v_and_b32 v233, s66, v236
    v_lshlrev_b32 v234, 16, v237
    v_and_b32 v235, s66, v237
    v_mul_f32 v232, s68, v232
    v_mul_f32 v233, s68, v233
    v_mul_f32 v234, s68, v234
    v_mul_f32 v235, s68, v235
    v_cvt_pk_bf16_f32 v180, v232, v233
    v_cvt_pk_bf16_f32 v181, v234, v235
    s_waitcnt vmcnt(27)
    v_mfma_f32_16x16x32_bf16 v[216:219], v[80:83], v[208:211], 0
    v_mfma_f32_16x16x32_bf16 v[216:219], v[84:87], v[212:215], v[216:219]
    v_mfma_f32_16x16x32_bf16 v[220:223], v[88:91], v[208:211], 0
    v_mfma_f32_16x16x32_bf16 v[220:223], v[92:95], v[212:215], v[220:223]
    s_waitcnt vmcnt(5)
    buffer_load_dwordx4 v[44:47], v6, s[40:43], s7 offen offset:2176 nt
    s_add_u32 s7, s7, 16384
    s_nop 3
    v_add_f32_dpp v238, v225, v224 row_ror:8 row_mask:0xf bank_mask:0xf
    v_add_f32_dpp v239, v227, v226 row_ror:8 row_mask:0xf bank_mask:0xf
    v_add_f32_dpp v240, v229, v228 row_ror:8 row_mask:0xf bank_mask:0xf
    v_add_f32_dpp v241, v231, v230 row_ror:8 row_mask:0xf bank_mask:0xf
    v_max3_f32 v10, v10, v238, v239
    v_cvt_pk_bf16_f32 v236, v238, v239
    v_cvt_pk_bf16_f32 v237, v240, v241
    v_max3_f32 v10, v10, v240, v241
    v_lshlrev_b32 v232, 16, v236
    v_and_b32 v233, s66, v236
    v_lshlrev_b32 v234, 16, v237
    v_and_b32 v235, s66, v237
    v_mul_f32 v232, s68, v232
    v_mul_f32 v233, s68, v233
    v_mul_f32 v234, s68, v234
    v_mul_f32 v235, s68, v235
    v_cvt_pk_bf16_f32 v182, v232, v233
    v_cvt_pk_bf16_f32 v183, v234, v235
    s_waitcnt vmcnt(24)
    v_mfma_f32_16x16x32_bf16 v[224:227], v[96:99], v[208:211], 0
    v_mfma_f32_16x16x32_bf16 v[224:227], v[100:103], v[212:215], v[224:227]
    v_mfma_f32_16x16x32_bf16 v[228:231], v[104:107], v[208:211], 0
    v_mfma_f32_16x16x32_bf16 v[228:231], v[108:111], v[212:215], v[228:231]
    s_waitcnt vmcnt(5)
    buffer_load_dwordx4 v[48:51], v6, s[40:43], s7 offen offset:0 nt
    s_nop 3
    v_add_f32_dpp v238, v217, v216 row_ror:8 row_mask:0xf bank_mask:0xf
    v_add_f32_dpp v239, v219, v218 row_ror:8 row_mask:0xf bank_mask:0xf
    v_add_f32_dpp v240, v221, v220 row_ror:8 row_mask:0xf bank_mask:0xf
    v_add_f32_dpp v241, v223, v222 row_ror:8 row_mask:0xf bank_mask:0xf
    v_max3_f32 v10, v10, v238, v239
    v_cvt_pk_bf16_f32 v236, v238, v239
    v_cvt_pk_bf16_f32 v237, v240, v241
    v_max3_f32 v10, v10, v240, v241
    v_lshlrev_b32 v232, 16, v236
    v_and_b32 v233, s66, v236
    v_lshlrev_b32 v234, 16, v237
    v_and_b32 v235, s66, v237
    v_mul_f32 v232, s68, v232
    v_mul_f32 v233, s68, v233
    v_mul_f32 v234, s68, v234
    v_mul_f32 v235, s68, v235
    v_cvt_pk_bf16_f32 v184, v232, v233
    v_cvt_pk_bf16_f32 v185, v234, v235
    s_waitcnt vmcnt(21)
    v_mfma_f32_16x16x32_bf16 v[216:219], v[112:115], v[208:211], 0
    v_mfma_f32_16x16x32_bf16 v[216:219], v[116:119], v[212:215], v[216:219]
    v_mfma_f32_16x16x32_bf16 v[220:223], v[120:123], v[208:211], 0
    v_mfma_f32_16x16x32_bf16 v[220:223], v[124:127], v[212:215], v[220:223]
    s_waitcnt vmcnt(5)
    buffer_load_dwordx4 v[52:55], v6, s[40:43], s7 offen offset:128 nt
    s_nop 3
    v_add_f32_dpp v238, v225, v224 row_ror:8 row_mask:0xf bank_mask:0xf
    v_add_f32_dpp v239, v227, v226 row_ror:8 row_mask:0xf bank_mask:0xf
    v_add_f32_dpp v240, v229, v228 row_ror:8 row_mask:0xf bank_mask:0xf
    v_add_f32_dpp v241, v231, v230 row_ror:8 row_mask:0xf bank_mask:0xf
    v_max3_f32 v10, v10, v238, v239
    v_cvt_pk_bf16_f32 v236, v238, v239
    v_cvt_pk_bf16_f32 v237, v240, v241
    v_max3_f32 v10, v10, v240, v241
    v_lshlrev_b32 v232, 16, v236
    v_and_b32 v233, s66, v236
    v_lshlrev_b32 v234, 16, v237
    v_and_b32 v235, s66, v237
    v_mul_f32 v232, s68, v232
    v_mul_f32 v233, s68, v233
    v_mul_f32 v234, s68, v234
    v_mul_f32 v235, s68, v235
    v_cvt_pk_bf16_f32 v186, v232, v233
    v_cvt_pk_bf16_f32 v187, v234, v235
    s_waitcnt vmcnt(18)
    v_mfma_f32_16x16x32_bf16 v[224:227], v[128:131], v[208:211], 0
    v_mfma_f32_16x16x32_bf16 v[224:227], v[132:135], v[212:215], v[224:227]
    v_mfma_f32_16x16x32_bf16 v[228:231], v[136:139], v[208:211], 0
    v_mfma_f32_16x16x32_bf16 v[228:231], v[140:143], v[212:215], v[228:231]
    s_waitcnt vmcnt(5)
    buffer_load_dwordx4 v[56:59], v6, s[40:43], s7 offen offset:2048 nt
    s_nop 3
    v_add_f32_dpp v238, v217, v216 row_ror:8 row_mask:0xf bank_mask:0xf
    v_add_f32_dpp v239, v219, v218 row_ror:8 row_mask:0xf bank_mask:0xf
    v_add_f32_dpp v240, v221, v220 row_ror:8 row_mask:0xf bank_mask:0xf
    v_add_f32_dpp v241, v223, v222 row_ror:8 row_mask:0xf bank_mask:0xf
    v_max3_f32 v10, v10, v238, v239
    v_cvt_pk_bf16_f32 v236, v238, v239
    v_cvt_pk_bf16_f32 v237, v240, v241
    v_max3_f32 v10, v10, v240, v241
    v_lshlrev_b32 v232, 16, v236
    v_and_b32 v233, s66, v236
    v_lshlrev_b32 v234, 16, v237
    v_and_b32 v235, s66, v237
    v_mul_f32 v232, s68, v232
    v_mul_f32 v233, s68, v233
    v_mul_f32 v234, s68, v234
    v_mul_f32 v235, s68, v235
    v_cvt_pk_bf16_f32 v188, v232, v233
    v_cvt_pk_bf16_f32 v189, v234, v235
    s_waitcnt vmcnt(15)
    v_mfma_f32_16x16x32_bf16 v[216:219], v[144:147], v[208:211], 0
    v_mfma_f32_16x16x32_bf16 v[216:219], v[148:151], v[212:215], v[216:219]
    v_mfma_f32_16x16x32_bf16 v[220:223], v[152:155], v[208:211], 0
    v_mfma_f32_16x16x32_bf16 v[220:223], v[156:159], v[212:215], v[220:223]
    s_waitcnt vmcnt(5)
    buffer_load_dwordx4 v[60:63], v6, s[40:43], s7 offen offset:2176 nt
    s_add_u32 s7, s7, 16384
    s_nop 3
    v_add_f32_dpp v238, v225, v224 row_ror:8 row_mask:0xf bank_mask:0xf
    v_add_f32_dpp v239, v227, v226 row_ror:8 row_mask:0xf bank_mask:0xf
    v_add_f32_dpp v240, v229, v228 row_ror:8 row_mask:0xf bank_mask:0xf
    v_add_f32_dpp v241, v231, v230 row_ror:8 row_mask:0xf bank_mask:0xf
    v_max3_f32 v10, v10, v238, v239
    v_cvt_pk_bf16_f32 v236, v238, v239
    v_cvt_pk_bf16_f32 v237, v240, v241
    v_max3_f32 v10, v10, v240, v241
    v_lshlrev_b32 v232, 16, v236
    v_and_b32 v233, s66, v236
    v_lshlrev_b32 v234, 16, v237
    v_and_b32 v235, s66, v237
    v_mul_f32 v232, s68, v232
    v_mul_f32 v233, s68, v233
    v_mul_f32 v234, s68, v234
    v_mul_f32 v235, s68, v235
    v_cvt_pk_bf16_f32 v190, v232, v233
    v_cvt_pk_bf16_f32 v191, v234, v235
    s_waitcnt vmcnt(12)
    v_mfma_f32_16x16x32_bf16 v[224:227], v[160:163], v[208:211], 0
    v_mfma_f32_16x16x32_bf16 v[224:227], v[164:167], v[212:215], v[224:227]
    v_mfma_f32_16x16x32_bf16 v[228:231], v[168:171], v[208:211], 0
    v_mfma_f32_16x16x32_bf16 v[228:231], v[172:175], v[212:215], v[228:231]
    s_waitcnt vmcnt(5)
    buffer_load_dwordx4 v[64:67], v6, s[40:43], s7 offen offset:0 nt
    s_nop 3
    v_add_f32_dpp v238, v217, v216 row_ror:8 row_mask:0xf bank_mask:0xf
    v_add_f32_dpp v239, v219, v218 row_ror:8 row_mask:0xf bank_mask:0xf
    v_add_f32_dpp v240, v221, v220 row_ror:8 row_mask:0xf bank_mask:0xf
    v_add_f32_dpp v241, v223, v222 row_ror:8 row_mask:0xf bank_mask:0xf
    v_max3_f32 v10, v10, v238, v239
    v_cvt_pk_bf16_f32 v236, v238, v239
    v_cvt_pk_bf16_f32 v237, v240, v241
    v_max3_f32 v10, v10, v240, v241
    v_lshlrev_b32 v232, 16, v236
    v_and_b32 v233, s66, v236
    v_lshlrev_b32 v234, 16, v237
    v_and_b32 v235, s66, v237
    v_mul_f32 v232, s68, v232
    v_mul_f32 v233, s68, v233
    v_mul_f32 v234, s68, v234
    v_mul_f32 v235, s68, v235
    v_cvt_pk_bf16_f32 v192, v232, v233
    v_cvt_pk_bf16_f32 v193, v234, v235
    s_waitcnt vmcnt(9)
    v_mfma_f32_16x16x32_bf16 v[216:219], v[16:19], v[208:211], 0
    v_mfma_f32_16x16x32_bf16 v[216:219], v[20:23], v[212:215], v[216:219]
    v_mfma_f32_16x16x32_bf16 v[220:223], v[24:27], v[208:211], 0
    v_mfma_f32_16x16x32_bf16 v[220:223], v[28:31], v[212:215], v[220:223]
    s_waitcnt vmcnt(5)
    buffer_load_dwordx4 v[68:71], v6, s[40:43], s7 offen offset:128 nt
    s_nop 3
    v_add_f32_dpp v238, v225, v224 row_ror:8 row_mask:0xf bank_mask:0xf
    v_add_f32_dpp v239, v227, v226 row_ror:8 row_mask:0xf bank_mask:0xf
    v_add_f32_dpp v240, v229, v228 row_ror:8 row_mask:0xf bank_mask:0xf
    v_add_f32_dpp v241, v231, v230 row_ror:8 row_mask:0xf bank_mask:0xf
    v_max3_f32 v10, v10, v238, v239
    v_cvt_pk_bf16_f32 v236, v238, v239
    v_cvt_pk_bf16_f32 v237, v240, v241
    v_max3_f32 v10, v10, v240, v241
    v_lshlrev_b32 v232, 16, v236
    v_and_b32 v233, s66, v236
    v_lshlrev_b32 v234, 16, v237
    v_and_b32 v235, s66, v237
    v_mul_f32 v232, s68, v232
    v_mul_f32 v233, s68, v233
    v_mul_f32 v234, s68, v234
    v_mul_f32 v235, s68, v235
    v_cvt_pk_bf16_f32 v194, v232, v233
    v_cvt_pk_bf16_f32 v195, v234, v235
    s_waitcnt vmcnt(6)
    v_mfma_f32_16x16x32_bf16 v[224:227], v[32:35], v[208:211], 0
    v_mfma_f32_16x16x32_bf16 v[224:227], v[36:39], v[212:215], v[224:227]
    v_mfma_f32_16x16x32_bf16 v[228:231], v[40:43], v[208:211], 0
    v_mfma_f32_16x16x32_bf16 v[228:231], v[44:47], v[212:215], v[228:231]
    s_waitcnt vmcnt(5)
    buffer_load_dwordx4 v[72:75], v6, s[40:43], s7 offen offset:2048 nt
    s_nop 3
    v_add_f32_dpp v238, v217, v216 row_ror:8 row_mask:0xf bank_mask:0xf
    v_add_f32_dpp v239, v219, v218 row_ror:8 row_mask:0xf bank_mask:0xf
    v_add_f32_dpp v240, v221, v220 row_ror:8 row_mask:0xf bank_mask:0xf
    v_add_f32_dpp v241, v223, v222 row_ror:8 row_mask:0xf bank_mask:0xf
    v_max3_f32 v10, v10, v238, v239
    v_cvt_pk_bf16_f32 v236, v238, v239
    v_cvt_pk_bf16_f32 v237, v240, v241
    v_max3_f32 v10, v10, v240, v241
    v_lshlrev_b32 v232, 16, v236
    v_and_b32 v233, s66, v236
    v_lshlrev_b32 v234, 16, v237
    v_and_b32 v235, s66, v237
    v_mul_f32 v232, s68, v232
    v_mul_f32 v233, s68, v233
    v_mul_f32 v234, s68, v234
    v_mul_f32 v235, s68, v235
    v_cvt_pk_bf16_f32 v196, v232, v233
    v_cvt_pk_bf16_f32 v197, v234, v235
    s_waitcnt vmcnt(5)
    buffer_load_dwordx4 v[76:79], v6, s[40:43], s7 offen offset:2176 nt
    s_add_u32 s7, s7, 16384
    s_waitcnt vmcnt(5)
    buffer_load_dwordx4 v[80:83], v6, s[40:43], s7 offen offset:0 nt
    s_waitcnt vmcnt(5)
    buffer_load_dwordx4 v[84:87], v6, s[40:43], s7 offen offset:128 nt
    v_mfma_f32_16x16x32_bf16 v[216:219], v[48:51], v[208:211], 0
    v_mfma_f32_16x16x32_bf16 v[216:219], v[52:55], v[212:215], v[216:219]
    v_mfma_f32_16x16x32_bf16 v[220:223], v[56:59], v[208:211], 0
    v_mfma_f32_16x16x32_bf16 v[220:223], v[60:63], v[212:215], v[220:223]
    s_waitcnt vmcnt(5)
    buffer_load_dwordx4 v[88:91], v6, s[40:43], s7 offen offset:2048 nt
    s_nop 3
    v_add_f32_dpp v238, v225, v224 row_ror:8 row_mask:0xf bank_mask:0xf
    v_add_f32_dpp v239, v227, v226 row_ror:8 row_mask:0xf bank_mask:0xf
    v_add_f32_dpp v240, v229, v228 row_ror:8 row_mask:0xf bank_mask:0xf
    v_add_f32_dpp v241, v231, v230 row_ror:8 row_mask:0xf bank_mask:0xf
    v_max3_f32 v10, v10, v238, v239
    v_cvt_pk_bf16_f32 v236, v238, v239
    v_cvt_pk_bf16_f32 v237, v240, v241
    v_max3_f32 v10, v10, v240, v241
    v_lshlrev_b32 v232, 16, v236
    v_and_b32 v233, s66, v236
    v_lshlrev_b32 v234, 16, v237
    v_and_b32 v235, s66, v237
    v_mul_f32 v232, s68, v232
    v_mul_f32 v233, s68, v233
    v_mul_f32 v234, s68, v234
    v_mul_f32 v235, s68, v235
    v_cvt_pk_bf16_f32 v198, v232, v233
    v_cvt_pk_bf16_f32 v199, v234, v235
    s_waitcnt vmcnt(5)
    buffer_load_dwordx4 v[92:95], v6, s[40:43], s7 offen offset:2176 nt
    s_add_u32 s7, s7, 16384
    s_waitcnt vmcnt(5)
    buffer_load_dwordx4 v[96:99], v6, s[40:43], s7 offen offset:0 nt
    s_waitcnt vmcnt(5)
    buffer_load_dwordx4 v[100:103], v6, s[40:43], s7 offen offset:128 nt
    v_mfma_f32_16x16x32_bf16 v[224:227], v[64:67], v[208:211], 0
    v_mfma_f32_16x16x32_bf16 v[224:227], v[68:71], v[212:215], v[224:227]
    v_mfma_f32_16x16x32_bf16 v[228:231], v[72:75], v[208:211], 0
    v_mfma_f32_16x16x32_bf16 v[228:231], v[76:79], v[212:215], v[228:231]
    s_waitcnt vmcnt(5)
    buffer_load_dwordx4 v[104:107], v6, s[40:43], s7 offen offset:2048 nt
    s_nop 3
    v_add_f32_dpp v238, v217, v216 row_ror:8 row_mask:0xf bank_mask:0xf
    v_add_f32_dpp v239, v219, v218 row_ror:8 row_mask:0xf bank_mask:0xf
    v_add_f32_dpp v240, v221, v220 row_ror:8 row_mask:0xf bank_mask:0xf
    v_add_f32_dpp v241, v223, v222 row_ror:8 row_mask:0xf bank_mask:0xf
    v_max3_f32 v10, v10, v238, v239
    v_cvt_pk_bf16_f32 v236, v238, v239
    v_cvt_pk_bf16_f32 v237, v240, v241
    v_max3_f32 v10, v10, v240, v241
    v_lshlrev_b32 v232, 16, v236
    v_and_b32 v233, s66, v236
    v_lshlrev_b32 v234, 16, v237
    v_and_b32 v235, s66, v237
    v_mul_f32 v232, s68, v232
    v_mul_f32 v233, s68, v233
    v_mul_f32 v234, s68, v234
    v_mul_f32 v235, s68, v235
    v_cvt_pk_bf16_f32 v200, v232, v233
    v_cvt_pk_bf16_f32 v201, v234, v235
    s_waitcnt vmcnt(5)
    buffer_load_dwordx4 v[108:111], v6, s[40:43], s7 offen offset:2176 nt
    s_waitcnt vmcnt(5)
    buffer_load_dwordx4 v[112:115], v7, s[44:47], s8 offen offset:0 nt
    s_waitcnt vmcnt(5)
    buffer_load_dwordx4 v[116:119], v7, s[44:47], s8 offen offset:1024 nt
    v_mfma_f32_16x16x32_bf16 v[216:219], v[80:83], v[208:211], 0
    v_mfma_f32_16x16x32_bf16 v[216:219], v[84:87], v[212:215], v[216:219]
    v_mfma_f32_16x16x32_bf16 v[220:223], v[88:91], v[208:211], 0
    v_mfma_f32_16x16x32_bf16 v[220:223], v[92:95], v[212:215], v[220:223]
    s_waitcnt vmcnt(5)
    buffer_load_dwordx4 v[120:123], v7, s[44:47], s8 offen offset:2048 nt
    s_nop 3
    v_add_f32_dpp v238, v225, v224 row_ror:8 row_mask:0xf bank_mask:0xf
    v_add_f32_dpp v239, v227, v226 row_ror:8 row_mask:0xf bank_mask:0xf
    v_add_f32_dpp v240, v229, v228 row_ror:8 row_mask:0xf bank_mask:0xf
    v_add_f32_dpp v241, v231, v230 row_ror:8 row_mask:0xf bank_mask:0xf
    v_max3_f32 v10, v10, v238, v239
    v_cvt_pk_bf16_f32 v236, v238, v239
    v_cvt_pk_bf16_f32 v237, v240, v241
    v_max3_f32 v10, v10, v240, v241
    v_lshlrev_b32 v232, 16, v236
    v_and_b32 v233, s66, v236
    v_lshlrev_b32 v234, 16, v237
    v_and_b32 v235, s66, v237
    v_mul_f32 v232, s68, v232
    v_mul_f32 v233, s68, v233
    v_mul_f32 v234, s68, v234
    v_mul_f32 v235, s68, v235
    v_cvt_pk_bf16_f32 v202, v232, v233
    v_cvt_pk_bf16_f32 v203, v234, v235
    s_waitcnt vmcnt(5)
    buffer_load_dwordx4 v[124:127], v7, s[44:47], s8 offen offset:3072 nt
    s_add_u32 s8, s8, 16384
    s_waitcnt vmcnt(5)
    buffer_load_dwordx4 v[128:131], v7, s[44:47], s8 offen offset:0 nt
    s_waitcnt vmcnt(5)
    buffer_load_dwordx4 v[132:135], v7, s[44:47], s8 offen offset:1024 nt
    v_mfma_f32_16x16x32_bf16 v[224:227], v[96:99], v[208:211], 0
    v_mfma_f32_16x16x32_bf16 v[224:227], v[100:103], v[212:215], v[224:227]
    v_mfma_f32_16x16x32_bf16 v[228:231], v[104:107], v[208:211], 0
    v_mfma_f32_16x16x32_bf16 v[228:231], v[108:111], v[212:215], v[228:231]
    s_waitcnt vmcnt(5)
    buffer_load_dwordx4 v[136:139], v7, s[44:47], s8 offen offset:2048 nt
    s_nop 3
    v_add_f32_dpp v238, v217, v216 row_ror:8 row_mask:0xf bank_mask:0xf
    v_add_f32_dpp v239, v219, v218 row_ror:8 row_mask:0xf bank_mask:0xf
    v_add_f32_dpp v240, v221, v220 row_ror:8 row_mask:0xf bank_mask:0xf
    v_add_f32_dpp v241, v223, v222 row_ror:8 row_mask:0xf bank_mask:0xf
    v_max3_f32 v10, v10, v238, v239
    v_cvt_pk_bf16_f32 v236, v238, v239
    v_cvt_pk_bf16_f32 v237, v240, v241
    v_max3_f32 v10, v10, v240, v241
    v_lshlrev_b32 v232, 16, v236
    v_and_b32 v233, s66, v236
    v_lshlrev_b32 v234, 16, v237
    v_and_b32 v235, s66, v237
    v_mul_f32 v232, s68, v232
    v_mul_f32 v233, s68, v233
    v_mul_f32 v234, s68, v234
    v_mul_f32 v235, s68, v235
    v_cvt_pk_bf16_f32 v204, v232, v233
    v_cvt_pk_bf16_f32 v205, v234, v235
    s_nop 7
    v_add_f32_dpp v238, v225, v224 row_ror:8 row_mask:0xf bank_mask:0xf
    v_add_f32_dpp v239, v227, v226 row_ror:8 row_mask:0xf bank_mask:0xf
    v_add_f32_dpp v240, v229, v228 row_ror:8 row_mask:0xf bank_mask:0xf
    v_add_f32_dpp v241, v231, v230 row_ror:8 row_mask:0xf bank_mask:0xf
    v_max3_f32 v10, v10, v238, v239
    v_cvt_pk_bf16_f32 v236, v238, v239
    v_cvt_pk_bf16_f32 v237, v240, v241
    v_max3_f32 v10, v10, v240, v241
    v_lshlrev_b32 v232, 16, v236
    v_and_b32 v233, s66, v236
    v_lshlrev_b32 v234, 16, v237
    v_and_b32 v235, s66, v237
    v_mul_f32 v232, s68, v232
    v_mul_f32 v233, s68, v233
    v_mul_f32 v234, s68, v234
    v_mul_f32 v235, s68, v235
    v_cvt_pk_bf16_f32 v206, v232, v233
    v_cvt_pk_bf16_f32 v207, v234, v235
    v_mov_b32 v11, v10
    s_nop 1
    v_permlane16_swap_b32 v10, v11
    v_max_f32 v10, v10, v11
    v_mov_b32 v11, v10
    s_nop 1
    v_permlane32_swap_b32 v10, v11
    v_max_f32 v10, v10, v11
    v_cvt_pk_bf16_f32 v224, v10, v10
    v_lshlrev_b32 v224, 16, v224
    v_mul_f32 v224, s68, v224
    v_cvt_pk_bf16_f32 v224, v224, v224
    v_lshlrev_b32 v224, 16, v224
    v_mul_f32 v11, s67, v224
    v_mov_b32 v225, 0
    v_mov_b32 v226, 0
    buffer_load_dwordx4 v[140:143], v7, s[44:47], s8 offen offset:3072 nt
    s_add_u32 s8, s8, 16384
    v_lshlrev_b32 v216, 16, v176
    v_and_b32 v217, s66, v176
    v_lshlrev_b32 v218, 16, v177
    v_and_b32 v219, s66, v177
    v_fma_f32 v216, v216, s67, -v11
    v_fma_f32 v217, v217, s67, -v11
    v_fma_f32 v218, v218, s67, -v11
    v_fma_f32 v219, v219, s67, -v11
    v_exp_f32 v216, v216
    v_exp_f32 v217, v217
    v_exp_f32 v218, v218
    v_exp_f32 v219, v219
    v_add_f32 v225, v225, v216
    v_add_f32 v226, v226, v217
    v_cvt_pk_bf16_f32 v176, v216, v217
    v_add_f32 v225, v225, v218
    v_add_f32 v226, v226, v219
    v_cvt_pk_bf16_f32 v177, v218, v219
    v_lshlrev_b32 v216, 16, v178
    v_and_b32 v217, s66, v178
    v_lshlrev_b32 v218, 16, v179
    v_and_b32 v219, s66, v179
    v_fma_f32 v216, v216, s67, -v11
    v_fma_f32 v217, v217, s67, -v11
    v_fma_f32 v218, v218, s67, -v11
    v_fma_f32 v219, v219, s67, -v11
    v_exp_f32 v216, v216
    v_exp_f32 v217, v217
    v_exp_f32 v218, v218
    v_exp_f32 v219, v219
    v_add_f32 v225, v225, v216
    v_add_f32 v226, v226, v217
    v_cvt_pk_bf16_f32 v178, v216, v217
    v_add_f32 v225, v225, v218
    v_add_f32 v226, v226, v219
    v_cvt_pk_bf16_f32 v179, v218, v219
    v_lshlrev_b32 v216, 16, v180
    v_and_b32 v217, s66, v180
    v_lshlrev_b32 v218, 16, v181
    v_and_b32 v219, s66, v181
    v_fma_f32 v216, v216, s67, -v11
    v_fma_f32 v217, v217, s67, -v11
    v_fma_f32 v218, v218, s67, -v11
    v_fma_f32 v219, v219, s67, -v11
    v_exp_f32 v216, v216
    v_exp_f32 v217, v217
    v_exp_f32 v218, v218
    v_exp_f32 v219, v219
    v_add_f32 v225, v225, v216
    v_add_f32 v226, v226, v217
    v_cvt_pk_bf16_f32 v180, v216, v217
    v_add_f32 v225, v225, v218
    v_add_f32 v226, v226, v219
    v_cvt_pk_bf16_f32 v181, v218, v219
    buffer_load_dwordx4 v[144:147], v7, s[44:47], s8 offen offset:0 nt
    v_lshlrev_b32 v216, 16, v182
    v_and_b32 v217, s66, v182
    v_lshlrev_b32 v218, 16, v183
    v_and_b32 v219, s66, v183
    v_fma_f32 v216, v216, s67, -v11
    v_fma_f32 v217, v217, s67, -v11
    v_fma_f32 v218, v218, s67, -v11
    v_fma_f32 v219, v219, s67, -v11
    v_exp_f32 v216, v216
    v_exp_f32 v217, v217
    v_exp_f32 v218, v218
    v_exp_f32 v219, v219
    v_add_f32 v225, v225, v216
    v_add_f32 v226, v226, v217
    v_cvt_pk_bf16_f32 v182, v216, v217
    v_add_f32 v225, v225, v218
    v_add_f32 v226, v226, v219
    v_cvt_pk_bf16_f32 v183, v218, v219
    v_lshlrev_b32 v216, 16, v184
    v_and_b32 v217, s66, v184
    v_lshlrev_b32 v218, 16, v185
    v_and_b32 v219, s66, v185
    v_fma_f32 v216, v216, s67, -v11
    v_fma_f32 v217, v217, s67, -v11
    v_fma_f32 v218, v218, s67, -v11
    v_fma_f32 v219, v219, s67, -v11
    v_exp_f32 v216, v216
    v_exp_f32 v217, v217
    v_exp_f32 v218, v218
    v_exp_f32 v219, v219
    v_add_f32 v225, v225, v216
    v_add_f32 v226, v226, v217
    v_cvt_pk_bf16_f32 v184, v216, v217
    v_add_f32 v225, v225, v218
    v_add_f32 v226, v226, v219
    v_cvt_pk_bf16_f32 v185, v218, v219
    v_lshlrev_b32 v216, 16, v186
    v_and_b32 v217, s66, v186
    v_lshlrev_b32 v218, 16, v187
    v_and_b32 v219, s66, v187
    v_fma_f32 v216, v216, s67, -v11
    v_fma_f32 v217, v217, s67, -v11
    v_fma_f32 v218, v218, s67, -v11
    v_fma_f32 v219, v219, s67, -v11
    v_exp_f32 v216, v216
    v_exp_f32 v217, v217
    v_exp_f32 v218, v218
    v_exp_f32 v219, v219
    v_add_f32 v225, v225, v216
    v_add_f32 v226, v226, v217
    v_cvt_pk_bf16_f32 v186, v216, v217
    v_add_f32 v225, v225, v218
    v_add_f32 v226, v226, v219
    v_cvt_pk_bf16_f32 v187, v218, v219
    buffer_load_dwordx4 v[148:151], v7, s[44:47], s8 offen offset:1024 nt
    v_lshlrev_b32 v216, 16, v188
    v_and_b32 v217, s66, v188
    v_lshlrev_b32 v218, 16, v189
    v_and_b32 v219, s66, v189
    v_fma_f32 v216, v216, s67, -v11
    v_fma_f32 v217, v217, s67, -v11
    v_fma_f32 v218, v218, s67, -v11
    v_fma_f32 v219, v219, s67, -v11
    v_exp_f32 v216, v216
    v_exp_f32 v217, v217
    v_exp_f32 v218, v218
    v_exp_f32 v219, v219
    v_add_f32 v225, v225, v216
    v_add_f32 v226, v226, v217
    v_cvt_pk_bf16_f32 v188, v216, v217
    v_add_f32 v225, v225, v218
    v_add_f32 v226, v226, v219
    v_cvt_pk_bf16_f32 v189, v218, v219
    v_lshlrev_b32 v216, 16, v190
    v_and_b32 v217, s66, v190
    v_lshlrev_b32 v218, 16, v191
    v_and_b32 v219, s66, v191
    v_fma_f32 v216, v216, s67, -v11
    v_fma_f32 v217, v217, s67, -v11
    v_fma_f32 v218, v218, s67, -v11
    v_fma_f32 v219, v219, s67, -v11
    v_exp_f32 v216, v216
    v_exp_f32 v217, v217
    v_exp_f32 v218, v218
    v_exp_f32 v219, v219
    v_add_f32 v225, v225, v216
    v_add_f32 v226, v226, v217
    v_cvt_pk_bf16_f32 v190, v216, v217
    v_add_f32 v225, v225, v218
    v_add_f32 v226, v226, v219
    v_cvt_pk_bf16_f32 v191, v218, v219
    v_lshlrev_b32 v216, 16, v192
    v_and_b32 v217, s66, v192
    v_lshlrev_b32 v218, 16, v193
    v_and_b32 v219, s66, v193
    v_fma_f32 v216, v216, s67, -v11
    v_fma_f32 v217, v217, s67, -v11
    v_fma_f32 v218, v218, s67, -v11
    v_fma_f32 v219, v219, s67, -v11
    v_exp_f32 v216, v216
    v_exp_f32 v217, v217
    v_exp_f32 v218, v218
    v_exp_f32 v219, v219
    v_add_f32 v225, v225, v216
    v_add_f32 v226, v226, v217
    v_cvt_pk_bf16_f32 v192, v216, v217
    v_add_f32 v225, v225, v218
    v_add_f32 v226, v226, v219
    v_cvt_pk_bf16_f32 v193, v218, v219
    buffer_load_dwordx4 v[152:155], v7, s[44:47], s8 offen offset:2048 nt
    v_lshlrev_b32 v216, 16, v194
    v_and_b32 v217, s66, v194
    v_lshlrev_b32 v218, 16, v195
    v_and_b32 v219, s66, v195
    v_fma_f32 v216, v216, s67, -v11
    v_fma_f32 v217, v217, s67, -v11
    v_fma_f32 v218, v218, s67, -v11
    v_fma_f32 v219, v219, s67, -v11
    v_exp_f32 v216, v216
    v_exp_f32 v217, v217
    v_exp_f32 v218, v218
    v_exp_f32 v219, v219
    v_add_f32 v225, v225, v216
    v_add_f32 v226, v226, v217
    v_cvt_pk_bf16_f32 v194, v216, v217
    v_add_f32 v225, v225, v218
    v_add_f32 v226, v226, v219
    v_cvt_pk_bf16_f32 v195, v218, v219
    v_lshlrev_b32 v216, 16, v196
    v_and_b32 v217, s66, v196
    v_lshlrev_b32 v218, 16, v197
    v_and_b32 v219, s66, v197
    v_fma_f32 v216, v216, s67, -v11
    v_fma_f32 v217, v217, s67, -v11
    v_fma_f32 v218, v218, s67, -v11
    v_fma_f32 v219, v219, s67, -v11
    v_exp_f32 v216, v216
    v_exp_f32 v217, v217
    v_exp_f32 v218, v218
    v_exp_f32 v219, v219
    v_add_f32 v225, v225, v216
    v_add_f32 v226, v226, v217
    v_cvt_pk_bf16_f32 v196, v216, v217
    v_add_f32 v225, v225, v218
    v_add_f32 v226, v226, v219
    v_cvt_pk_bf16_f32 v197, v218, v219
    v_lshlrev_b32 v216, 16, v198
    v_and_b32 v217, s66, v198
    v_lshlrev_b32 v218, 16, v199
    v_and_b32 v219, s66, v199
    v_fma_f32 v216, v216, s67, -v11
    v_fma_f32 v217, v217, s67, -v11
    v_fma_f32 v218, v218, s67, -v11
    v_fma_f32 v219, v219, s67, -v11
    v_exp_f32 v216, v216
    v_exp_f32 v217, v217
    v_exp_f32 v218, v218
    v_exp_f32 v219, v219
    v_add_f32 v225, v225, v216
    v_add_f32 v226, v226, v217
    v_cvt_pk_bf16_f32 v198, v216, v217
    v_add_f32 v225, v225, v218
    v_add_f32 v226, v226, v219
    v_cvt_pk_bf16_f32 v199, v218, v219
    buffer_load_dwordx4 v[156:159], v7, s[44:47], s8 offen offset:3072 nt
    s_add_u32 s8, s8, 16384
    v_lshlrev_b32 v216, 16, v200
    v_and_b32 v217, s66, v200
    v_lshlrev_b32 v218, 16, v201
    v_and_b32 v219, s66, v201
    v_fma_f32 v216, v216, s67, -v11
    v_fma_f32 v217, v217, s67, -v11
    v_fma_f32 v218, v218, s67, -v11
    v_fma_f32 v219, v219, s67, -v11
    v_exp_f32 v216, v216
    v_exp_f32 v217, v217
    v_exp_f32 v218, v218
    v_exp_f32 v219, v219
    v_add_f32 v225, v225, v216
    v_add_f32 v226, v226, v217
    v_cvt_pk_bf16_f32 v200, v216, v217
    v_add_f32 v225, v225, v218
    v_add_f32 v226, v226, v219
    v_cvt_pk_bf16_f32 v201, v218, v219
    v_lshlrev_b32 v216, 16, v202
    v_and_b32 v217, s66, v202
    v_lshlrev_b32 v218, 16, v203
    v_and_b32 v219, s66, v203
    v_fma_f32 v216, v216, s67, -v11
    v_fma_f32 v217, v217, s67, -v11
    v_fma_f32 v218, v218, s67, -v11
    v_fma_f32 v219, v219, s67, -v11
    v_exp_f32 v216, v216
    v_exp_f32 v217, v217
    v_exp_f32 v218, v218
    v_exp_f32 v219, v219
    v_add_f32 v225, v225, v216
    v_add_f32 v226, v226, v217
    v_cvt_pk_bf16_f32 v202, v216, v217
    v_add_f32 v225, v225, v218
    v_add_f32 v226, v226, v219
    v_cvt_pk_bf16_f32 v203, v218, v219
    v_lshlrev_b32 v216, 16, v204
    v_and_b32 v217, s66, v204
    v_lshlrev_b32 v218, 16, v205
    v_and_b32 v219, s66, v205
    v_fma_f32 v216, v216, s67, -v11
    v_fma_f32 v217, v217, s67, -v11
    v_fma_f32 v218, v218, s67, -v11
    v_fma_f32 v219, v219, s67, -v11
    v_exp_f32 v216, v216
    v_exp_f32 v217, v217
    v_exp_f32 v218, v218
    v_exp_f32 v219, v219
    v_add_f32 v225, v225, v216
    v_add_f32 v226, v226, v217
    v_cvt_pk_bf16_f32 v204, v216, v217
    v_add_f32 v225, v225, v218
    v_add_f32 v226, v226, v219
    v_cvt_pk_bf16_f32 v205, v218, v219
    buffer_load_dwordx4 v[160:163], v7, s[44:47], s8 offen offset:0 nt
    v_lshlrev_b32 v216, 16, v206
    v_and_b32 v217, s66, v206
    v_lshlrev_b32 v218, 16, v207
    v_and_b32 v219, s66, v207
    v_fma_f32 v216, v216, s67, -v11
    v_fma_f32 v217, v217, s67, -v11
    v_fma_f32 v218, v218, s67, -v11
    v_fma_f32 v219, v219, s67, -v11
    v_exp_f32 v216, v216
    v_exp_f32 v217, v217
    v_exp_f32 v218, v218
    v_exp_f32 v219, v219
    v_add_f32 v225, v225, v216
    v_add_f32 v226, v226, v217
    v_cvt_pk_bf16_f32 v206, v216, v217
    v_add_f32 v225, v225, v218
    v_add_f32 v226, v226, v219
    v_cvt_pk_bf16_f32 v207, v218, v219
    v_add_f32 v225, v225, v226
    v_mov_b32 v226, v225
    s_nop 1
    v_permlane16_swap_b32 v225, v226
    v_add_f32 v225, v225, v226
    v_mov_b32 v226, v225
    s_nop 1
    v_permlane32_swap_b32 v225, v226
    v_add_f32 v225, v225, v226
    v_min_u32 v225, -2, v225
    s_lshl_b32 s9, s6, 6
    v_lshlrev_b32 v12, 3, v0
    v_add_u32 v12, s9, v12
    s_mov_b64 exec, 0xff
    ds_write_b64 v12, v[224:225] offset:3200
    s_mov_b64 exec, -1
    buffer_load_dwordx4 v[164:167], v7, s[44:47], s8 offen offset:1024 nt
    s_and_b32 s4, s6, 1
    s_lshr_b32 s5, s6, 1
    s_mul_i32 s9, s6, 4224
    v_mul_u32_u24 v10, 528, v4
    v_lshl_add_u32 v10, v5, 7, v10
    v_add_u32 v10, s9, v10
    v_lshrrev_b32 v3, 1, v5
    v_lshlrev_b32 v3, 5, v3
    v_and_b32 v1, 1, v5
    v_lshl_add_u32 v3, v1, 2, v3
    v_lshl_add_u32 v3, v8, 1, v3
    v_lshlrev_b32 v3, 11, v3
    v_lshl_add_u32 v3, v9, 4, v3
    v_lshl_add_u32 v1, v5, 1, v8
    v_mul_u32_u24 v1, 14336, v1
    v_lshl_add_u32 v1, v9, 4, v1
    s_lshl1_add_u32 s12, s96, s4
    s_lshl_b32 s12, s12, 7
    s_lshl1_add_u32 s13, s97, s5
    s_lshl_b32 s11, s13, 17
    s_add_u32 s11, s11, s12
    s_mul_i32 s10, s13, 114688
    s_add_u32 s10, s10, s12
    v_bfe_u32 v12, v4, 2, 1
    v_lshlrev_b32 v12, 8, v12
    v_lshl_add_u32 v12, v5, 5, v12
    v_and_b32 v11, 1, v4
    v_lshl_add_u32 v12, v11, 4, v12
    s_lshl_b32 s9, s5, 7
    v_add_u32 v12, s9, v12
    v_lshlrev_b32 v11, 15, v5
    v_lshrrev_b32 v6, 2, v9
    v_lshl_add_u32 v11, v6, 13, v11
    v_and_b32 v6, 3, v9
    v_lshl_add_u32 v11, v6, 5, v11
    v_lshl_add_u32 v11, v8, 4, v11
    s_lshl_b32 s9, s96, 16
    s_lshl_b32 s12, s4, 14
    s_add_u32 s9, s9, s12
    s_lshl_b32 s12, s13, 7
    s_add_u32 s9, s9, s12
    s_add_u32 s9, s9, 1572864
    v_lshrrev_b32 v4, 5, v0
    s_lshl_b32 s12, s6, 1
    v_add_u32 v4, s12, v4
    v_lshlrev_b32 v5, 4, v4
    v_mul_u32_u24 v4, 528, v4
    v_and_b32 v6, 31, v0
    v_lshl_add_u32 v4, v6, 4, v4
    v_lshlrev_b32 v8, 4, v9
    v_lshrrev_b32 v6, 3, v0
    v_lshl_add_u32 v8, v6, 12, v8
    v_mul_u32_u24 v6, 5, v6
    v_add_u32 v6, s97, v6
    v_and_b32 v6, 31, v6
    v_lshl_add_u32 v8, v6, 7, v8
    s_lshl_b32 s5, s96, 17
    s_lshl_b32 s12, s6, 15
    s_add_u32 s5, s5, s12
    s_add_u32 s5, s5, 524288
    s_mov_b32 s15, 16000000
L_poll43:
    ds_read_b32 v6, v14 offset:3524
    s_waitcnt lgkmcnt(0)
    v_readfirstlane_b32 s101, v6
    s_cmp_lg_u32 s101, -1
    s_cbranch_scc1 L_pdone44
    s_sub_u32 s15, s15, 1
    s_cbranch_scc1 L_pdone44
    s_sleep 2
    s_branch L_poll43
L_pdone44:
    s_mov_b32 s100, 0
    ds_read_b32 v2, v14 offset:3520
    s_waitcnt vmcnt(10)
    s_waitcnt lgkmcnt(0)
    v_readfirstlane_b32 s100, v2
    ds_read_b32 v2, v14 offset:3520
    s_waitcnt vmcnt(7)
    s_bitcmp1_b32 s100, 1
    s_cbranch_scc1 L_go45
    s_waitcnt vmcnt(6)
    s_bitcmp1_b32 s100, 0
    s_cbranch_scc1 L_go45
    s_waitcnt vmcnt(5)
L_go45:
    buffer_load_dwordx4 v[168:171], v7, s[44:47], s8 offen offset:2048 nt
    s_waitcnt vmcnt(7)
    s_bitcmp1_b32 s100, 1
    s_cbranch_scc1 L_go46
    s_waitcnt vmcnt(6)
    s_bitcmp1_b32 s100, 0
    s_cbranch_scc1 L_go46
    s_waitcnt vmcnt(5)
L_go46:
    buffer_load_dwordx4 v[172:175], v7, s[44:47], s8 offen offset:3072 nt
    s_add_u32 s8, s8, 16384
    v_perm_b32 v240, v116, v112, s64
    v_perm_b32 v241, v124, v120, s64
    v_perm_b32 v242, v132, v128, s64
    v_perm_b32 v243, v140, v136, s64
    v_perm_b32 v244, v116, v112, s65
    v_perm_b32 v245, v124, v120, s65
    v_perm_b32 v246, v132, v128, s65
    v_perm_b32 v247, v140, v136, s65
    v_perm_b32 v248, v117, v113, s64
    v_perm_b32 v249, v125, v121, s64
    v_perm_b32 v250, v133, v129, s64
    v_perm_b32 v251, v141, v137, s64
    v_perm_b32 v252, v117, v113, s65
    v_perm_b32 v253, v125, v121, s65
    v_perm_b32 v254, v133, v129, s65
    v_perm_b32 v255, v141, v137, s65
    v_mfma_f32_16x16x32_bf16 v[208:211], v[240:243], v[176:179], 0
    v_mfma_f32_16x16x32_bf16 v[212:215], v[244:247], v[176:179], 0
    v_perm_b32 v240, v118, v114, s64
    v_perm_b32 v241, v126, v122, s64
    v_perm_b32 v242, v134, v130, s64
    v_perm_b32 v243, v142, v138, s64
    v_perm_b32 v244, v118, v114, s65
    v_perm_b32 v245, v126, v122, s65
    v_perm_b32 v246, v134, v130, s65
    v_perm_b32 v247, v142, v138, s65
    v_mfma_f32_16x16x32_bf16 v[216:219], v[248:251], v[176:179], 0
    v_mfma_f32_16x16x32_bf16 v[220:223], v[252:255], v[176:179], 0
    v_perm_b32 v248, v119, v115, s64
    v_perm_b32 v249, v127, v123, s64
    v_perm_b32 v250, v135, v131, s64
    v_perm_b32 v251, v143, v139, s64
    v_perm_b32 v252, v119, v115, s65
    v_perm_b32 v253, v127, v123, s65
    v_perm_b32 v254, v135, v131, s65
    v_perm_b32 v255, v143, v139, s65
    v_mfma_f32_16x16x32_bf16 v[224:227], v[240:243], v[176:179], 0
    v_mfma_f32_16x16x32_bf16 v[228:231], v[244:247], v[176:179], 0
    v_mfma_f32_16x16x32_bf16 v[232:235], v[248:251], v[176:179], 0
    v_mfma_f32_16x16x32_bf16 v[236:239], v[252:255], v[176:179], 0
    s_waitcnt lgkmcnt(0)
    v_readfirstlane_b32 s100, v2
    ds_read_b32 v2, v14 offset:3520
    s_waitcnt vmcnt(7)
    s_bitcmp1_b32 s100, 1
    s_cbranch_scc1 L_go47
    s_waitcnt vmcnt(6)
    s_bitcmp1_b32 s100, 0
    s_cbranch_scc1 L_go47
    s_waitcnt vmcnt(5)
L_go47:
    buffer_load_dwordx4 v[16:19], v7, s[44:47], s8 offen offset:0 nt
    s_waitcnt vmcnt(7)
    s_bitcmp1_b32 s100, 1
    s_cbranch_scc1 L_go48
    s_waitcnt vmcnt(6)
    s_bitcmp1_b32 s100, 0
    s_cbranch_scc1 L_go48
    s_waitcnt vmcnt(5)
L_go48:
    buffer_load_dwordx4 v[20:23], v7, s[44:47], s8 offen offset:1024 nt
    s_waitcnt vmcnt(7)
    s_bitcmp1_b32 s100, 1
    s_cbranch_scc1 L_go49
    s_waitcnt vmcnt(6)
    s_bitcmp1_b32 s100, 0
    s_cbranch_scc1 L_go49
    s_waitcnt vmcnt(5)
L_go49:
    buffer_load_dwordx4 v[24:27], v7, s[44:47], s8 offen offset:2048 nt
    s_waitcnt vmcnt(7)
    s_bitcmp1_b32 s100, 1
    s_cbranch_scc1 L_go50
    s_waitcnt vmcnt(6)
    s_bitcmp1_b32 s100, 0
    s_cbranch_scc1 L_go50
    s_waitcnt vmcnt(5)
L_go50:
    buffer_load_dwordx4 v[28:31], v7, s[44:47], s8 offen offset:3072 nt
    s_add_u32 s8, s8, 16384
    s_waitcnt lgkmcnt(0)
    v_readfirstlane_b32 s100, v2
    ds_read_b32 v2, v14 offset:3520
    s_waitcnt vmcnt(7)
    s_bitcmp1_b32 s100, 1
    s_cbranch_scc1 L_go51
    s_waitcnt vmcnt(6)
    s_bitcmp1_b32 s100, 0
    s_cbranch_scc1 L_go51
    s_waitcnt vmcnt(5)
L_go51:
    buffer_load_dwordx4 v[32:35], v7, s[44:47], s8 offen offset:0 nt
    s_waitcnt vmcnt(7)
    s_bitcmp1_b32 s100, 1
    s_cbranch_scc1 L_go52
    s_waitcnt vmcnt(6)
    s_bitcmp1_b32 s100, 0
    s_cbranch_scc1 L_go52
    s_waitcnt vmcnt(5)
L_go52:
    buffer_load_dwordx4 v[36:39], v7, s[44:47], s8 offen offset:1024 nt
    s_waitcnt vmcnt(7)
    s_bitcmp1_b32 s100, 1
    s_cbranch_scc1 L_go53
    s_waitcnt vmcnt(6)
    s_bitcmp1_b32 s100, 0
    s_cbranch_scc1 L_go53
    s_waitcnt vmcnt(5)
L_go53:
    buffer_load_dwordx4 v[40:43], v7, s[44:47], s8 offen offset:2048 nt
    s_waitcnt vmcnt(7)
    s_bitcmp1_b32 s100, 1
    s_cbranch_scc1 L_go54
    s_waitcnt vmcnt(6)
    s_bitcmp1_b32 s100, 0
    s_cbranch_scc1 L_go54
    s_waitcnt vmcnt(5)
L_go54:
    buffer_load_dwordx4 v[44:47], v7, s[44:47], s8 offen offset:3072 nt
    s_add_u32 s8, s8, 16384
    v_perm_b32 v240, v148, v144, s64
    v_perm_b32 v241, v156, v152, s64
    v_perm_b32 v242, v164, v160, s64
    v_perm_b32 v243, v172, v168, s64
    v_perm_b32 v244, v148, v144, s65
    v_perm_b32 v245, v156, v152, s65
    v_perm_b32 v246, v164, v160, s65
    v_perm_b32 v247, v172, v168, s65
    v_perm_b32 v248, v149, v145, s64
    v_perm_b32 v249, v157, v153, s64
    v_perm_b32 v250, v165, v161, s64
    v_perm_b32 v251, v173, v169, s64
    v_perm_b32 v252, v149, v145, s65
    v_perm_b32 v253, v157, v153, s65
    v_perm_b32 v254, v165, v161, s65
    v_perm_b32 v255, v173, v169, s65
    v_mfma_f32_16x16x32_bf16 v[208:211], v[240:243], v[180:183], v[208:211]
    v_mfma_f32_16x16x32_bf16 v[212:215], v[244:247], v[180:183], v[212:215]
    v_perm_b32 v240, v150, v146, s64
    v_perm_b32 v241, v158, v154, s64
    v_perm_b32 v242, v166, v162, s64
    v_perm_b32 v243, v174, v170, s64
    v_perm_b32 v244, v150, v146, s65
    v_perm_b32 v245, v158, v154, s65
    v_perm_b32 v246, v166, v162, s65
    v_perm_b32 v247, v174, v170, s65
    v_mfma_f32_16x16x32_bf16 v[216:219], v[248:251], v[180:183], v[216:219]
    v_mfma_f32_16x16x32_bf16 v[220:223], v[252:255], v[180:183], v[220:223]
    v_perm_b32 v248, v151, v147, s64
    v_perm_b32 v249, v159, v155, s64
    v_perm_b32 v250, v167, v163, s64
    v_perm_b32 v251, v175, v171, s64
    v_perm_b32 v252, v151, v147, s65
    v_perm_b32 v253, v159, v155, s65
    v_perm_b32 v254, v167, v163, s65
    v_perm_b32 v255, v175, v171, s65
    v_mfma_f32_16x16x32_bf16 v[224:227], v[240:243], v[180:183], v[224:227]
    v_mfma_f32_16x16x32_bf16 v[228:231], v[244:247], v[180:183], v[228:231]
    v_mfma_f32_16x16x32_bf16 v[232:235], v[248:251], v[180:183], v[232:235]
    v_mfma_f32_16x16x32_bf16 v[236:239], v[252:255], v[180:183], v[236:239]
    s_waitcnt lgkmcnt(0)
    v_readfirstlane_b32 s100, v2
    ds_read_b32 v2, v14 offset:3520
    s_waitcnt vmcnt(7)
    s_bitcmp1_b32 s100, 1
    s_cbranch_scc1 L_go55
    s_waitcnt vmcnt(6)
    s_bitcmp1_b32 s100, 0
    s_cbranch_scc1 L_go55
    s_waitcnt vmcnt(5)
L_go55:
    buffer_load_dwordx4 v[48:51], v7, s[44:47], s8 offen offset:0 nt
    s_waitcnt vmcnt(7)
    s_bitcmp1_b32 s100, 1
    s_cbranch_scc1 L_go56
    s_waitcnt vmcnt(6)
    s_bitcmp1_b32 s100, 0
    s_cbranch_scc1 L_go56
    s_waitcnt vmcnt(5)
L_go56:
    buffer_load_dwordx4 v[52:55], v7, s[44:47], s8 offen offset:1024 nt
    s_waitcnt vmcnt(7)
    s_bitcmp1_b32 s100, 1
    s_cbranch_scc1 L_go57
    s_waitcnt vmcnt(6)
    s_bitcmp1_b32 s100, 0
    s_cbranch_scc1 L_go57
    s_waitcnt vmcnt(5)
L_go57:
    buffer_load_dwordx4 v[56:59], v7, s[44:47], s8 offen offset:2048 nt
    s_waitcnt vmcnt(7)
    s_bitcmp1_b32 s100, 1
    s_cbranch_scc1 L_go58
    s_waitcnt vmcnt(6)
    s_bitcmp1_b32 s100, 0
    s_cbranch_scc1 L_go58
    s_waitcnt vmcnt(5)
L_go58:
    buffer_load_dwordx4 v[60:63], v7, s[44:47], s8 offen offset:3072 nt
    s_add_u32 s8, s8, 16384
    s_waitcnt lgkmcnt(0)
    v_readfirstlane_b32 s100, v2
    ds_read_b32 v2, v14 offset:3520
    s_waitcnt vmcnt(7)
    s_bitcmp1_b32 s100, 1
    s_cbranch_scc1 L_go59
    s_waitcnt vmcnt(6)
    s_bitcmp1_b32 s100, 0
    s_cbranch_scc1 L_go59
    s_waitcnt vmcnt(5)
L_go59:
    buffer_load_dwordx4 v[64:67], v7, s[44:47], s8 offen offset:0 nt
    s_waitcnt vmcnt(7)
    s_bitcmp1_b32 s100, 1
    s_cbranch_scc1 L_go60
    s_waitcnt vmcnt(6)
    s_bitcmp1_b32 s100, 0
    s_cbranch_scc1 L_go60
    s_waitcnt vmcnt(5)
L_go60:
    buffer_load_dwordx4 v[68:71], v7, s[44:47], s8 offen offset:1024 nt
    s_waitcnt vmcnt(7)
    s_bitcmp1_b32 s100, 1
    s_cbranch_scc1 L_go61
    s_waitcnt vmcnt(6)
    s_bitcmp1_b32 s100, 0
    s_cbranch_scc1 L_go61
    s_waitcnt vmcnt(5)
L_go61:
    buffer_load_dwordx4 v[72:75], v7, s[44:47], s8 offen offset:2048 nt
    s_waitcnt vmcnt(7)
    s_bitcmp1_b32 s100, 1
    s_cbranch_scc1 L_go62
    s_waitcnt vmcnt(6)
    s_bitcmp1_b32 s100, 0
    s_cbranch_scc1 L_go62
    s_waitcnt vmcnt(5)
L_go62:
    buffer_load_dwordx4 v[76:79], v7, s[44:47], s8 offen offset:3072 nt
    s_add_u32 s8, s8, 16384
    v_perm_b32 v240, v20, v16, s64
    v_perm_b32 v241, v28, v24, s64
    v_perm_b32 v242, v36, v32, s64
    v_perm_b32 v243, v44, v40, s64
    v_perm_b32 v244, v20, v16, s65
    v_perm_b32 v245, v28, v24, s65
    v_perm_b32 v246, v36, v32, s65
    v_perm_b32 v247, v44, v40, s65
    v_perm_b32 v248, v21, v17, s64
    v_perm_b32 v249, v29, v25, s64
    v_perm_b32 v250, v37, v33, s64
    v_perm_b32 v251, v45, v41, s64
    v_perm_b32 v252, v21, v17, s65
    v_perm_b32 v253, v29, v25, s65
    v_perm_b32 v254, v37, v33, s65
    v_perm_b32 v255, v45, v41, s65
    v_mfma_f32_16x16x32_bf16 v[208:211], v[240:243], v[184:187], v[208:211]
    v_mfma_f32_16x16x32_bf16 v[212:215], v[244:247], v[184:187], v[212:215]
    v_perm_b32 v240, v22, v18, s64
    v_perm_b32 v241, v30, v26, s64
    v_perm_b32 v242, v38, v34, s64
    v_perm_b32 v243, v46, v42, s64
    v_perm_b32 v244, v22, v18, s65
    v_perm_b32 v245, v30, v26, s65
    v_perm_b32 v246, v38, v34, s65
    v_perm_b32 v247, v46, v42, s65
    v_mfma_f32_16x16x32_bf16 v[216:219], v[248:251], v[184:187], v[216:219]
    v_mfma_f32_16x16x32_bf16 v[220:223], v[252:255], v[184:187], v[220:223]
    v_perm_b32 v248, v23, v19, s64
    v_perm_b32 v249, v31, v27, s64
    v_perm_b32 v250, v39, v35, s64
    v_perm_b32 v251, v47, v43, s64
    v_perm_b32 v252, v23, v19, s65
    v_perm_b32 v253, v31, v27, s65
    v_perm_b32 v254, v39, v35, s65
    v_perm_b32 v255, v47, v43, s65
    v_mfma_f32_16x16x32_bf16 v[224:227], v[240:243], v[184:187], v[224:227]
    v_mfma_f32_16x16x32_bf16 v[228:231], v[244:247], v[184:187], v[228:231]
    v_mfma_f32_16x16x32_bf16 v[232:235], v[248:251], v[184:187], v[232:235]
    v_mfma_f32_16x16x32_bf16 v[236:239], v[252:255], v[184:187], v[236:239]
    s_waitcnt lgkmcnt(0)
    v_readfirstlane_b32 s100, v2
    ds_read_b32 v2, v14 offset:3520
    s_waitcnt vmcnt(7)
    s_bitcmp1_b32 s100, 1
    s_cbranch_scc1 L_go63
    s_waitcnt vmcnt(6)
    s_bitcmp1_b32 s100, 0
    s_cbranch_scc1 L_go63
    s_waitcnt vmcnt(5)
L_go63:
    buffer_load_dwordx4 v[80:83], v7, s[44:47], s8 offen offset:0 nt
    s_waitcnt vmcnt(7)
    s_bitcmp1_b32 s100, 1
    s_cbranch_scc1 L_go64
    s_waitcnt vmcnt(6)
    s_bitcmp1_b32 s100, 0
    s_cbranch_scc1 L_go64
    s_waitcnt vmcnt(5)
L_go64:
    buffer_load_dwordx4 v[84:87], v7, s[44:47], s8 offen offset:1024 nt
    s_waitcnt vmcnt(7)
    s_bitcmp1_b32 s100, 1
    s_cbranch_scc1 L_go65
    s_waitcnt vmcnt(6)
    s_bitcmp1_b32 s100, 0
    s_cbranch_scc1 L_go65
    s_waitcnt vmcnt(5)
L_go65:
    buffer_load_dwordx4 v[88:91], v7, s[44:47], s8 offen offset:2048 nt
    s_waitcnt vmcnt(7)
    s_bitcmp1_b32 s100, 1
    s_cbranch_scc1 L_go66
    s_waitcnt vmcnt(6)
    s_bitcmp1_b32 s100, 0
    s_cbranch_scc1 L_go66
    s_waitcnt vmcnt(5)
L_go66:
    buffer_load_dwordx4 v[92:95], v7, s[44:47], s8 offen offset:3072 nt
    s_add_u32 s8, s8, 16384
    s_waitcnt lgkmcnt(0)
    v_readfirstlane_b32 s100, v2
    ds_read_b32 v2, v14 offset:3520
    s_waitcnt vmcnt(7)
    s_bitcmp1_b32 s100, 1
    s_cbranch_scc1 L_go67
    s_waitcnt vmcnt(6)
    s_bitcmp1_b32 s100, 0
    s_cbranch_scc1 L_go67
    s_waitcnt vmcnt(5)
L_go67:
    buffer_load_dwordx4 v[96:99], v7, s[44:47], s8 offen offset:0 nt
    s_waitcnt vmcnt(7)
    s_bitcmp1_b32 s100, 1
    s_cbranch_scc1 L_go68
    s_waitcnt vmcnt(6)
    s_bitcmp1_b32 s100, 0
    s_cbranch_scc1 L_go68
    s_waitcnt vmcnt(5)
L_go68:
    buffer_load_dwordx4 v[100:103], v7, s[44:47], s8 offen offset:1024 nt
    s_waitcnt vmcnt(7)
    s_bitcmp1_b32 s100, 1
    s_cbranch_scc1 L_go69
    s_waitcnt vmcnt(6)
    s_bitcmp1_b32 s100, 0
    s_cbranch_scc1 L_go69
    s_waitcnt vmcnt(5)
L_go69:
    buffer_load_dwordx4 v[104:107], v7, s[44:47], s8 offen offset:2048 nt
    s_waitcnt vmcnt(7)
    s_bitcmp1_b32 s100, 1
    s_cbranch_scc1 L_go70
    s_waitcnt vmcnt(6)
    s_bitcmp1_b32 s100, 0
    s_cbranch_scc1 L_go70
    s_waitcnt vmcnt(5)
L_go70:
    buffer_load_dwordx4 v[108:111], v7, s[44:47], s8 offen offset:3072 nt
    s_add_u32 s8, s8, 16384
    v_perm_b32 v240, v52, v48, s64
    v_perm_b32 v241, v60, v56, s64
    v_perm_b32 v242, v68, v64, s64
    v_perm_b32 v243, v76, v72, s64
    v_perm_b32 v244, v52, v48, s65
    v_perm_b32 v245, v60, v56, s65
    v_perm_b32 v246, v68, v64, s65
    v_perm_b32 v247, v76, v72, s65
    v_perm_b32 v248, v53, v49, s64
    v_perm_b32 v249, v61, v57, s64
    v_perm_b32 v250, v69, v65, s64
    v_perm_b32 v251, v77, v73, s64
    v_perm_b32 v252, v53, v49, s65
    v_perm_b32 v253, v61, v57, s65
    v_perm_b32 v254, v69, v65, s65
    v_perm_b32 v255, v77, v73, s65
    v_mfma_f32_16x16x32_bf16 v[208:211], v[240:243], v[188:191], v[208:211]
    v_mfma_f32_16x16x32_bf16 v[212:215], v[244:247], v[188:191], v[212:215]
    v_perm_b32 v240, v54, v50, s64
    v_perm_b32 v241, v62, v58, s64
    v_perm_b32 v242, v70, v66, s64
    v_perm_b32 v243, v78, v74, s64
    v_perm_b32 v244, v54, v50, s65
    v_perm_b32 v245, v62, v58, s65
    v_perm_b32 v246, v70, v66, s65
    v_perm_b32 v247, v78, v74, s65
    v_mfma_f32_16x16x32_bf16 v[216:219], v[248:251], v[188:191], v[216:219]
    v_mfma_f32_16x16x32_bf16 v[220:223], v[252:255], v[188:191], v[220:223]
    v_perm_b32 v248, v55, v51, s64
    v_perm_b32 v249, v63, v59, s64
    v_perm_b32 v250, v71, v67, s64
    v_perm_b32 v251, v79, v75, s64
    v_perm_b32 v252, v55, v51, s65
    v_perm_b32 v253, v63, v59, s65
    v_perm_b32 v254, v71, v67, s65
    v_perm_b32 v255, v79, v75, s65
    v_mfma_f32_16x16x32_bf16 v[224:227], v[240:243], v[188:191], v[224:227]
    v_mfma_f32_16x16x32_bf16 v[228:231], v[244:247], v[188:191], v[228:231]
    v_mfma_f32_16x16x32_bf16 v[232:235], v[248:251], v[188:191], v[232:235]
    v_mfma_f32_16x16x32_bf16 v[236:239], v[252:255], v[188:191], v[236:239]
    s_waitcnt vmcnt(7)
    s_bitcmp1_b32 s100, 1
    s_cbranch_scc1 L_go71
    s_waitcnt vmcnt(6)
    s_bitcmp1_b32 s100, 0
    s_cbranch_scc1 L_go71
    s_waitcnt vmcnt(5)
L_go71:
    buffer_load_dwordx4 v[112:115], v7, s[44:47], s8 offen offset:0 nt
    s_waitcnt vmcnt(7)
    s_bitcmp1_b32 s100, 1
    s_cbranch_scc1 L_go72
    s_waitcnt vmcnt(6)
    s_bitcmp1_b32 s100, 0
    s_cbranch_scc1 L_go72
    s_waitcnt vmcnt(5)
L_go72:
    buffer_load_dwordx4 v[116:119], v7, s[44:47], s8 offen offset:1024 nt
    s_waitcnt vmcnt(7)
    s_bitcmp1_b32 s100, 1
    s_cbranch_scc1 L_go73
    s_waitcnt vmcnt(6)
    s_bitcmp1_b32 s100, 0
    s_cbranch_scc1 L_go73
    s_waitcnt vmcnt(5)
L_go73:
    buffer_load_dwordx4 v[120:123], v7, s[44:47], s8 offen offset:2048 nt
    s_waitcnt vmcnt(7)
    s_bitcmp1_b32 s100, 1
    s_cbranch_scc1 L_go74
    s_waitcnt vmcnt(6)
    s_bitcmp1_b32 s100, 0
    s_cbranch_scc1 L_go74
    s_waitcnt vmcnt(5)
L_go74:
    buffer_load_dwordx4 v[124:127], v7, s[44:47], s8 offen offset:3072 nt
    s_add_u32 s8, s8, 16384
    ds_write_b32 v14, v14 offset:3476
    s_waitcnt vmcnt(7)
    s_bitcmp1_b32 s100, 1
    s_cbranch_scc1 L_go75
    s_waitcnt vmcnt(6)
    s_bitcmp1_b32 s100, 0
    s_cbranch_scc1 L_go75
    s_waitcnt vmcnt(5)
L_go75:
    buffer_load_dwordx4 v[128:131], v7, s[44:47], s8 offen offset:0 nt
    s_waitcnt vmcnt(7)
    s_bitcmp1_b32 s100, 1
    s_cbranch_scc1 L_go76
    s_waitcnt vmcnt(6)
    s_bitcmp1_b32 s100, 0
    s_cbranch_scc1 L_go76
    s_waitcnt vmcnt(5)
L_go76:
    buffer_load_dwordx4 v[132:135], v7, s[44:47], s8 offen offset:1024 nt
    s_waitcnt vmcnt(7)
    s_bitcmp1_b32 s100, 1
    s_cbranch_scc1 L_go77
    s_waitcnt vmcnt(6)
    s_bitcmp1_b32 s100, 0
    s_cbranch_scc1 L_go77
    s_waitcnt vmcnt(5)
L_go77:
    buffer_load_dwordx4 v[136:139], v7, s[44:47], s8 offen offset:2048 nt
    s_waitcnt vmcnt(7)
    s_bitcmp1_b32 s100, 1
    s_cbranch_scc1 L_go78
    s_waitcnt vmcnt(6)
    s_bitcmp1_b32 s100, 0
    s_cbranch_scc1 L_go78
    s_waitcnt vmcnt(5)
L_go78:
    buffer_load_dwordx4 v[140:143], v7, s[44:47], s8 offen offset:3072 nt
    s_add_u32 s8, s8, 16384
    v_perm_b32 v240, v84, v80, s64
    v_perm_b32 v241, v92, v88, s64
    v_perm_b32 v242, v100, v96, s64
    v_perm_b32 v243, v108, v104, s64
    v_perm_b32 v244, v84, v80, s65
    v_perm_b32 v245, v92, v88, s65
    v_perm_b32 v246, v100, v96, s65
    v_perm_b32 v247, v108, v104, s65
    v_perm_b32 v248, v85, v81, s64
    v_perm_b32 v249, v93, v89, s64
    v_perm_b32 v250, v101, v97, s64
    v_perm_b32 v251, v109, v105, s64
    v_perm_b32 v252, v85, v81, s65
    v_perm_b32 v253, v93, v89, s65
    v_perm_b32 v254, v101, v97, s65
    v_perm_b32 v255, v109, v105, s65
    v_mfma_f32_16x16x32_bf16 v[208:211], v[240:243], v[192:195], v[208:211]
    v_mfma_f32_16x16x32_bf16 v[212:215], v[244:247], v[192:195], v[212:215]
    v_perm_b32 v240, v86, v82, s64
    v_perm_b32 v241, v94, v90, s64
    v_perm_b32 v242, v102, v98, s64
    v_perm_b32 v243, v110, v106, s64
    v_perm_b32 v244, v86, v82, s65
    v_perm_b32 v245, v94, v90, s65
    v_perm_b32 v246, v102, v98, s65
    v_perm_b32 v247, v110, v106, s65
    v_mfma_f32_16x16x32_bf16 v[216:219], v[248:251], v[192:195], v[216:219]
    v_mfma_f32_16x16x32_bf16 v[220:223], v[252:255], v[192:195], v[220:223]
    v_perm_b32 v248, v87, v83, s64
    v_perm_b32 v249, v95, v91, s64
    v_perm_b32 v250, v103, v99, s64
    v_perm_b32 v251, v111, v107, s64
    v_perm_b32 v252, v87, v83, s65
    v_perm_b32 v253, v95, v91, s65
    v_perm_b32 v254, v103, v99, s65
    v_perm_b32 v255, v111, v107, s65
    v_mfma_f32_16x16x32_bf16 v[224:227], v[240:243], v[192:195], v[224:227]
    v_mfma_f32_16x16x32_bf16 v[228:231], v[244:247], v[192:195], v[228:231]
    v_mfma_f32_16x16x32_bf16 v[232:235], v[248:251], v[192:195], v[232:235]
    v_mfma_f32_16x16x32_bf16 v[236:239], v[252:255], v[192:195], v[236:239]
    s_waitcnt vmcnt(7)
    s_bitcmp1_b32 s100, 1
    s_cbranch_scc1 L_go79
    s_waitcnt vmcnt(6)
    s_bitcmp1_b32 s100, 0
    s_cbranch_scc1 L_go79
    s_waitcnt vmcnt(5)
L_go79:
    buffer_load_dwordx4 v[144:147], v7, s[44:47], s8 offen offset:0 nt
    s_waitcnt vmcnt(7)
    s_bitcmp1_b32 s100, 1
    s_cbranch_scc1 L_go80
    s_waitcnt vmcnt(6)
    s_bitcmp1_b32 s100, 0
    s_cbranch_scc1 L_go80
    s_waitcnt vmcnt(5)
L_go80:
    buffer_load_dwordx4 v[148:151], v7, s[44:47], s8 offen offset:1024 nt
    s_waitcnt vmcnt(7)
    s_bitcmp1_b32 s100, 1
    s_cbranch_scc1 L_go81
    s_waitcnt vmcnt(6)
    s_bitcmp1_b32 s100, 0
    s_cbranch_scc1 L_go81
    s_waitcnt vmcnt(5)
L_go81:
    buffer_load_dwordx4 v[152:155], v7, s[44:47], s8 offen offset:2048 nt
    s_waitcnt vmcnt(7)
    s_bitcmp1_b32 s100, 1
    s_cbranch_scc1 L_go82
    s_waitcnt vmcnt(6)
    s_bitcmp1_b32 s100, 0
    s_cbranch_scc1 L_go82
    s_waitcnt vmcnt(5)
L_go82:
    buffer_load_dwordx4 v[156:159], v7, s[44:47], s8 offen offset:3072 nt
    s_add_u32 s8, s8, 16384
    s_waitcnt vmcnt(7)
    s_bitcmp1_b32 s100, 1
    s_cbranch_scc1 L_go83
    s_waitcnt vmcnt(6)
    s_bitcmp1_b32 s100, 0
    s_cbranch_scc1 L_go83
    s_waitcnt vmcnt(5)
L_go83:
    buffer_load_dwordx4 v[160:163], v7, s[44:47], s8 offen offset:0 nt
    s_waitcnt vmcnt(7)
    s_bitcmp1_b32 s100, 1
    s_cbranch_scc1 L_go84
    s_waitcnt vmcnt(6)
    s_bitcmp1_b32 s100, 0
    s_cbranch_scc1 L_go84
    s_waitcnt vmcnt(5)
L_go84:
    buffer_load_dwordx4 v[164:167], v7, s[44:47], s8 offen offset:1024 nt
    s_waitcnt vmcnt(7)
    s_bitcmp1_b32 s100, 1
    s_cbranch_scc1 L_go85
    s_waitcnt vmcnt(6)
    s_bitcmp1_b32 s100, 0
    s_cbranch_scc1 L_go85
    s_waitcnt vmcnt(5)
L_go85:
    buffer_load_dwordx4 v[168:171], v7, s[44:47], s8 offen offset:2048 nt
    s_waitcnt vmcnt(7)
    s_bitcmp1_b32 s100, 1
    s_cbranch_scc1 L_go86
    s_waitcnt vmcnt(6)
    s_bitcmp1_b32 s100, 0
    s_cbranch_scc1 L_go86
    s_waitcnt vmcnt(5)
L_go86:
    buffer_load_dwordx4 v[172:175], v7, s[44:47], s8 offen offset:3072 nt
    s_add_u32 s8, s8, 16384
    v_perm_b32 v240, v116, v112, s64
    v_perm_b32 v241, v124, v120, s64
    v_perm_b32 v242, v132, v128, s64
    v_perm_b32 v243, v140, v136, s64
    v_perm_b32 v244, v116, v112, s65
    v_perm_b32 v245, v124, v120, s65
    v_perm_b32 v246, v132, v128, s65
    v_perm_b32 v247, v140, v136, s65
    v_perm_b32 v248, v117, v113, s64
    v_perm_b32 v249, v125, v121, s64
    v_perm_b32 v250, v133, v129, s64
    v_perm_b32 v251, v141, v137, s64
    v_perm_b32 v252, v117, v113, s65
    v_perm_b32 v253, v125, v121, s65
    v_perm_b32 v254, v133, v129, s65
    v_perm_b32 v255, v141, v137, s65
    v_mfma_f32_16x16x32_bf16 v[208:211], v[240:243], v[196:199], v[208:211]
    v_mfma_f32_16x16x32_bf16 v[212:215], v[244:247], v[196:199], v[212:215]
    v_perm_b32 v240, v118, v114, s64
    v_perm_b32 v241, v126, v122, s64
    v_perm_b32 v242, v134, v130, s64
    v_perm_b32 v243, v142, v138, s64
    v_perm_b32 v244, v118, v114, s65
    v_perm_b32 v245, v126, v122, s65
    v_perm_b32 v246, v134, v130, s65
    v_perm_b32 v247, v142, v138, s65
    v_mfma_f32_16x16x32_bf16 v[216:219], v[248:251], v[196:199], v[216:219]
    v_mfma_f32_16x16x32_bf16 v[220:223], v[252:255], v[196:199], v[220:223]
    v_perm_b32 v248, v119, v115, s64
    v_perm_b32 v249, v127, v123, s64
    v_perm_b32 v250, v135, v131, s64
    v_perm_b32 v251, v143, v139, s64
    v_perm_b32 v252, v119, v115, s65
    v_perm_b32 v253, v127, v123, s65
    v_perm_b32 v254, v135, v131, s65
    v_perm_b32 v255, v143, v139, s65
    v_mfma_f32_16x16x32_bf16 v[224:227], v[240:243], v[196:199], v[224:227]
    v_mfma_f32_16x16x32_bf16 v[228:231], v[244:247], v[196:199], v[228:231]
    v_mfma_f32_16x16x32_bf16 v[232:235], v[248:251], v[196:199], v[232:235]
    v_mfma_f32_16x16x32_bf16 v[236:239], v[252:255], v[196:199], v[236:239]
    s_waitcnt vmcnt(7)
    s_bitcmp1_b32 s100, 1
    s_cbranch_scc1 L_go87
    s_waitcnt vmcnt(6)
    s_bitcmp1_b32 s100, 0
    s_cbranch_scc1 L_go87
    s_waitcnt vmcnt(5)
L_go87:
    buffer_load_dwordx4 v[16:19], v7, s[44:47], s8 offen offset:0 nt
    s_waitcnt vmcnt(7)
    s_bitcmp1_b32 s100, 1
    s_cbranch_scc1 L_go88
    s_waitcnt vmcnt(6)
    s_bitcmp1_b32 s100, 0
    s_cbranch_scc1 L_go88
    s_waitcnt vmcnt(5)
L_go88:
    buffer_load_dwordx4 v[20:23], v7, s[44:47], s8 offen offset:1024 nt
    s_waitcnt vmcnt(7)
    s_bitcmp1_b32 s100, 1
    s_cbranch_scc1 L_go89
    s_waitcnt vmcnt(6)
    s_bitcmp1_b32 s100, 0
    s_cbranch_scc1 L_go89
    s_waitcnt vmcnt(5)
L_go89:
    buffer_load_dwordx4 v[24:27], v7, s[44:47], s8 offen offset:2048 nt
    s_waitcnt vmcnt(7)
    s_bitcmp1_b32 s100, 1
    s_cbranch_scc1 L_go90
    s_waitcnt vmcnt(6)
    s_bitcmp1_b32 s100, 0
    s_cbranch_scc1 L_go90
    s_waitcnt vmcnt(5)
L_go90:
    buffer_load_dwordx4 v[28:31], v7, s[44:47], s8 offen offset:3072 nt
    s_add_u32 s8, s8, 16384
    s_waitcnt vmcnt(7)
    s_bitcmp1_b32 s100, 1
    s_cbranch_scc1 L_go91
    s_waitcnt vmcnt(6)
    s_bitcmp1_b32 s100, 0
    s_cbranch_scc1 L_go91
    s_waitcnt vmcnt(5)
L_go91:
    buffer_load_dwordx4 v[32:35], v7, s[44:47], s8 offen offset:0 nt
    s_waitcnt vmcnt(7)
    s_bitcmp1_b32 s100, 1
    s_cbranch_scc1 L_go92
    s_waitcnt vmcnt(6)
    s_bitcmp1_b32 s100, 0
    s_cbranch_scc1 L_go92
    s_waitcnt vmcnt(5)
L_go92:
    buffer_load_dwordx4 v[36:39], v7, s[44:47], s8 offen offset:1024 nt
    s_waitcnt vmcnt(7)
    s_bitcmp1_b32 s100, 1
    s_cbranch_scc1 L_go93
    s_waitcnt vmcnt(6)
    s_bitcmp1_b32 s100, 0
    s_cbranch_scc1 L_go93
    s_waitcnt vmcnt(5)
L_go93:
    buffer_load_dwordx4 v[40:43], v7, s[44:47], s8 offen offset:2048 nt
    s_waitcnt vmcnt(7)
    s_bitcmp1_b32 s100, 1
    s_cbranch_scc1 L_go94
    s_waitcnt vmcnt(6)
    s_bitcmp1_b32 s100, 0
    s_cbranch_scc1 L_go94
    s_waitcnt vmcnt(5)
L_go94:
    buffer_load_dwordx4 v[44:47], v7, s[44:47], s8 offen offset:3072 nt
    ds_write_b32 v13, v14 offset:3552
    v_perm_b32 v240, v148, v144, s64
    v_perm_b32 v241, v156, v152, s64
    v_perm_b32 v242, v164, v160, s64
    v_perm_b32 v243, v172, v168, s64
    v_perm_b32 v244, v148, v144, s65
    v_perm_b32 v245, v156, v152, s65
    v_perm_b32 v246, v164, v160, s65
    v_perm_b32 v247, v172, v168, s65
    v_perm_b32 v248, v149, v145, s64
    v_perm_b32 v249, v157, v153, s64
    v_perm_b32 v250, v165, v161, s64
    v_perm_b32 v251, v173, v169, s64
    v_perm_b32 v252, v149, v145, s65
    v_perm_b32 v253, v157, v153, s65
    v_perm_b32 v254, v165, v161, s65
    v_perm_b32 v255, v173, v169, s65
    v_mfma_f32_16x16x32_bf16 v[208:211], v[240:243], v[200:203], v[208:211]
    v_mfma_f32_16x16x32_bf16 v[212:215], v[244:247], v[200:203], v[212:215]
    v_perm_b32 v240, v150, v146, s64
    v_perm_b32 v241, v158, v154, s64
    v_perm_b32 v242, v166, v162, s64
    v_perm_b32 v243, v174, v170, s64
    v_perm_b32 v244, v150, v146, s65
    v_perm_b32 v245, v158, v154, s65
    v_perm_b32 v246, v166, v162, s65
    v_perm_b32 v247, v174, v170, s65
    v_mfma_f32_16x16x32_bf16 v[216:219], v[248:251], v[200:203], v[216:219]
    v_mfma_f32_16x16x32_bf16 v[220:223], v[252:255], v[200:203], v[220:223]
    v_perm_b32 v248, v151, v147, s64
    v_perm_b32 v249, v159, v155, s64
    v_perm_b32 v250, v167, v163, s64
    v_perm_b32 v251, v175, v171, s64
    v_perm_b32 v252, v151, v147, s65
    v_perm_b32 v253, v159, v155, s65
    v_perm_b32 v254, v167, v163, s65
    v_perm_b32 v255, v175, v171, s65
    v_mfma_f32_16x16x32_bf16 v[224:227], v[240:243], v[200:203], v[224:227]
    v_mfma_f32_16x16x32_bf16 v[228:231], v[244:247], v[200:203], v[228:231]
    v_mfma_f32_16x16x32_bf16 v[232:235], v[248:251], v[200:203], v[232:235]
    v_mfma_f32_16x16x32_bf16 v[236:239], v[252:255], v[200:203], v[236:239]
    s_waitcnt vmcnt(4)
    s_waitcnt vmcnt(0)
    v_perm_b32 v240, v20, v16, s64
    v_perm_b32 v241, v28, v24, s64
    v_perm_b32 v242, v36, v32, s64
    v_perm_b32 v243, v44, v40, s64
    v_perm_b32 v244, v20, v16, s65
    v_perm_b32 v245, v28, v24, s65
    v_perm_b32 v246, v36, v32, s65
    v_perm_b32 v247, v44, v40, s65
    v_perm_b32 v248, v21, v17, s64
    v_perm_b32 v249, v29, v25, s64
    v_perm_b32 v250, v37, v33, s64
    v_perm_b32 v251, v45, v41, s64
    v_perm_b32 v252, v21, v17, s65
    v_perm_b32 v253, v29, v25, s65
    v_perm_b32 v254, v37, v33, s65
    v_perm_b32 v255, v45, v41, s65
    v_mfma_f32_16x16x32_bf16 v[208:211], v[240:243], v[204:207], v[208:211]
    v_mfma_f32_16x16x32_bf16 v[212:215], v[244:247], v[204:207], v[212:215]
    v_perm_b32 v240, v22, v18, s64
    v_perm_b32 v241, v30, v26, s64
    v_perm_b32 v242, v38, v34, s64
    v_perm_b32 v243, v46, v42, s64
    v_perm_b32 v244, v22, v18, s65
    v_perm_b32 v245, v30, v26, s65
    v_perm_b32 v246, v38, v34, s65
    v_perm_b32 v247, v46, v42, s65
    v_mfma_f32_16x16x32_bf16 v[216:219], v[248:251], v[204:207], v[216:219]
    v_mfma_f32_16x16x32_bf16 v[220:223], v[252:255], v[204:207], v[220:223]
    v_perm_b32 v248, v23, v19, s64
    v_perm_b32 v249, v31, v27, s64
    v_perm_b32 v250, v39, v35, s64
    v_perm_b32 v251, v47, v43, s64
    v_perm_b32 v252, v23, v19, s65
    v_perm_b32 v253, v31, v27, s65
    v_perm_b32 v254, v39, v35, s65
    v_perm_b32 v255, v47, v43, s65
    v_mfma_f32_16x16x32_bf16 v[224:227], v[240:243], v[204:207], v[224:227]
    v_mfma_f32_16x16x32_bf16 v[228:231], v[244:247], v[204:207], v[228:231]
    v_mfma_f32_16x16x32_bf16 v[232:235], v[248:251], v[204:207], v[232:235]
    v_mfma_f32_16x16x32_bf16 v[236:239], v[252:255], v[204:207], v[236:239]
    s_mov_b32 exec_lo, 0x00ff00ff
    s_mov_b32 exec_hi, 0x00ff00ff
    ds_write_b128 v10, v[208:211] offset:4864
    ds_write_b128 v10, v[212:215] offset:4880
    ds_write_b128 v10, v[216:219] offset:4896
    ds_write_b128 v10, v[220:223] offset:4912
    s_nop 0
    ds_write_b128 v10, v[224:227] offset:4928
    ds_write_b128 v10, v[228:231] offset:4944
    ds_write_b128 v10, v[232:235] offset:4960
    ds_write_b128 v10, v[236:239] offset:4976
    s_mov_b64 exec, -1
    ds_write_b32 v13, v14 offset:3456
    s_mov_b32 s15, 16000000
L_poll95:
    ds_read_b128 v[16:19], v14 offset:3456
    ds_read_b32 v20, v14 offset:3472
    s_waitcnt lgkmcnt(0)
    v_or3_b32 v16, v16, v17, v18
    v_or3_b32 v16, v16, v19, v20
    v_cmp_eq_u32 vcc, 0, v16
    s_cmp_eq_u64 vcc, -1
    s_cbranch_scc1 L_pdone96
    s_sub_u32 s15, s15, 1
    s_cbranch_scc1 L_pdone96
    s_branch L_poll95
L_pdone96:
    ds_read_b128 v[16:19], v5 offset:3712
    ds_read_b128 v[20:23], v4 offset:4864
    ds_read_b128 v[24:27], v4 offset:9088
    ds_read_b128 v[28:31], v4 offset:13312
    ds_read_b128 v[32:35], v4 offset:17536
    v_mov_b32 v108, 0
    v_mov_b32 v109, 0
    v_mov_b32 v110, 0
    v_mov_b32 v111, 0
    s_waitcnt lgkmcnt(0)
    v_mul_f32 v20, v16, v20
    v_mul_f32 v21, v16, v21
    v_mul_f32 v22, v16, v22
    v_mul_f32 v23, v16, v23
    v_fmac_f32 v20, v17, v24
    v_fmac_f32 v21, v17, v25
    v_fmac_f32 v22, v17, v26
    v_fmac_f32 v23, v17, v27
    v_fmac_f32 v20, v18, v28
    v_fmac_f32 v21, v18, v29
    v_fmac_f32 v22, v18, v30
    v_fmac_f32 v23, v18, v31
    v_fmac_f32 v20, v19, v32
    v_fmac_f32 v21, v19, v33
    v_fmac_f32 v22, v19, v34
    v_fmac_f32 v23, v19, v35
    v_bfi_b32 v20, s69, v15, v20
    v_bfi_b32 v21, s69, v15, v21
    v_bfi_b32 v22, s69, v15, v22
    v_bfi_b32 v23, s69, v15, v23
    s_cmp_eq_u32 s101, 1
    s_cbranch_scc1 L_stf97
    buffer_store_dwordx4 v[20:23], v8, s[48:51], s5 offen sc1
    s_branch L_std98
L_stf97:
    buffer_store_dwordx4 v[20:23], v8, s[48:51], s5 offen
L_std98:
    s_mov_b32 s15, 16000000
L_poll99:
    ds_read_b64 v[240:241], v14 offset:3480
    s_waitcnt lgkmcnt(0)
    v_or_b32 v240, v240, v241
    v_cmp_eq_u32 vcc, 0, v240
    s_cmp_eq_u64 vcc, -1
    s_cbranch_scc1 L_pdone100
    s_sub_u32 s15, s15, 1
    s_cbranch_scc1 L_pdone100
    s_sleep 1
    s_branch L_poll99
L_pdone100:
    buffer_load_dwordx4 v[48:51], v3, s[52:55], s11 offen offset:0 nt
    buffer_load_dwordx4 v[52:55], v3, s[52:55], s11 offen offset:2048 nt
    s_add_u32 s11, s11, 16384
    buffer_load_dwordx4 v[56:59], v3, s[52:55], s11 offen offset:0 nt
    buffer_load_dwordx4 v[60:63], v3, s[52:55], s11 offen offset:2048 nt
    s_add_u32 s11, s11, 16384
    buffer_load_dwordx4 v[64:67], v3, s[52:55], s11 offen offset:0 nt
    buffer_load_dwordx4 v[68:71], v3, s[52:55], s11 offen offset:2048 nt
    s_add_u32 s11, s11, 16384
    s_bitcmp1_b32 s100, 1
    s_cbranch_scc1 L_go101
    s_waitcnt vmcnt(6)
    s_bitcmp1_b32 s100, 0
    s_cbranch_scc1 L_go101
    s_waitcnt vmcnt(5)
L_go101:
    buffer_load_dwordx4 v[72:75], v3, s[52:55], s11 offen offset:0 nt
    s_bitcmp1_b32 s100, 1
    s_cbranch_scc1 L_go102
    s_waitcnt vmcnt(6)
    s_bitcmp1_b32 s100, 0
    s_cbranch_scc1 L_go102
    s_waitcnt vmcnt(5)
L_go102:
    buffer_load_dwordx4 v[76:79], v3, s[52:55], s11 offen offset:2048 nt
    s_waitcnt vmcnt(7)
    s_bitcmp1_b32 s100, 1
    s_cbranch_scc1 L_go103
    s_waitcnt vmcnt(6)
    s_bitcmp1_b32 s100, 0
    s_cbranch_scc1 L_go103
    s_waitcnt vmcnt(5)
L_go103:
    buffer_load_dwordx4 v[80:83], v1, s[56:59], s10 offen offset:0 nt
    s_waitcnt vmcnt(7)
    s_bitcmp1_b32 s100, 1
    s_cbranch_scc1 L_go104
    s_waitcnt vmcnt(6)
    s_bitcmp1_b32 s100, 0
    s_cbranch_scc1 L_go104
    s_waitcnt vmcnt(5)
L_go104:
    buffer_load_dwordx4 v[84:87], v1, s[56:59], s10 offen offset:2048 nt
    s_add_u32 s10, s10, 4096
    s_waitcnt vmcnt(7)
    s_bitcmp1_b32 s100, 1
    s_cbranch_scc1 L_go105
    s_waitcnt vmcnt(6)
    s_bitcmp1_b32 s100, 0
    s_cbranch_scc1 L_go105
    s_waitcnt vmcnt(5)
L_go105:
    buffer_load_dwordx4 v[88:91], v1, s[56:59], s10 offen offset:0 nt
    ds_write_b32 v13, v14 offset:3584
    s_waitcnt vmcnt(7)
    s_bitcmp1_b32 s100, 1
    s_cbranch_scc1 L_go106
    s_waitcnt vmcnt(6)
    s_bitcmp1_b32 s100, 0
    s_cbranch_scc1 L_go106
    s_waitcnt vmcnt(5)
L_go106:
    buffer_load_dwordx4 v[92:95], v1, s[56:59], s10 offen offset:2048 nt
    s_add_u32 s10, s10, 4096
    s_waitcnt vmcnt(7)
    s_bitcmp1_b32 s100, 1
    s_cbranch_scc1 L_go107
    s_waitcnt vmcnt(6)
    s_bitcmp1_b32 s100, 0
    s_cbranch_scc1 L_go107
    s_waitcnt vmcnt(5)
L_go107:
    buffer_load_dwordx4 v[96:99], v1, s[56:59], s10 offen offset:0 nt
    s_waitcnt vmcnt(7)
    s_bitcmp1_b32 s100, 1
    s_cbranch_scc1 L_go108
    s_waitcnt vmcnt(6)
    s_bitcmp1_b32 s100, 0
    s_cbranch_scc1 L_go108
    s_waitcnt vmcnt(5)
L_go108:
    buffer_load_dwordx4 v[100:103], v1, s[56:59], s10 offen offset:2048 nt
    s_add_u32 s10, s10, 4096
    s_waitcnt vmcnt(7)
    s_bitcmp1_b32 s100, 1
    s_cbranch_scc1 L_go109
    s_waitcnt vmcnt(6)
    s_bitcmp1_b32 s100, 0
    s_cbranch_scc1 L_go109
    s_waitcnt vmcnt(5)
L_go109:
    buffer_load_dwordx4 v[104:107], v1, s[56:59], s10 offen offset:0 nt
    ds_write_b32 v13, v14 offset:3536
    s_waitcnt vmcnt(7)
    v_perm_b32 v112, v56, v48, s64
    v_perm_b32 v113, v72, v64, s64
    v_perm_b32 v114, v60, v52, s64
    v_perm_b32 v115, v76, v68, s64
    v_perm_b32 v116, v56, v48, s65
    v_perm_b32 v117, v72, v64, s65
    v_perm_b32 v118, v60, v52, s65
    v_perm_b32 v119, v76, v68, s65
    v_perm_b32 v120, v57, v49, s64
    v_perm_b32 v121, v73, v65, s64
    v_perm_b32 v122, v61, v53, s64
    v_perm_b32 v123, v77, v69, s64
    v_perm_b32 v124, v57, v49, s65
    v_perm_b32 v125, v73, v65, s65
    v_perm_b32 v126, v61, v53, s65
    v_perm_b32 v127, v77, v69, s65
    v_perm_b32 v128, v58, v50, s64
    v_perm_b32 v129, v74, v66, s64
    v_perm_b32 v130, v62, v54, s64
    v_perm_b32 v131, v78, v70, s64
    v_perm_b32 v132, v58, v50, s65
    v_perm_b32 v133, v74, v66, s65
    v_perm_b32 v134, v62, v54, s65
    v_perm_b32 v135, v78, v70, s65
    v_perm_b32 v136, v59, v51, s64
    v_perm_b32 v137, v75, v67, s64
    v_perm_b32 v138, v63, v55, s64
    v_perm_b32 v139, v79, v71, s64
    v_perm_b32 v140, v59, v51, s65
    v_perm_b32 v141, v75, v67, s65
    v_perm_b32 v142, v63, v55, s65
    v_perm_b32 v143, v79, v71, s65
    s_waitcnt vmcnt(3)
    v_perm_b32 v144, v84, v80, s64
    v_perm_b32 v145, v92, v88, s64
    v_perm_b32 v148, v84, v80, s65
    v_perm_b32 v149, v92, v88, s65
    v_perm_b32 v152, v85, v81, s64
    v_perm_b32 v153, v93, v89, s64
    v_perm_b32 v156, v85, v81, s65
    v_perm_b32 v157, v93, v89, s65
    v_perm_b32 v160, v86, v82, s64
    v_perm_b32 v161, v94, v90, s64
    v_perm_b32 v164, v86, v82, s65
    v_perm_b32 v165, v94, v90, s65
    v_perm_b32 v168, v87, v83, s64
    v_perm_b32 v169, v95, v91, s64
    v_perm_b32 v172, v87, v83, s65
    v_perm_b32 v173, v95, v91, s65
    s_waitcnt vmcnt(0)
    ds_read_b32 v248, v14 offset:3508
    ds_read_b128 v[244:247], v12 offset:3840
    v_perm_b32 v146, v100, v96, s64
    v_perm_b32 v147, v108, v104, s64
    v_perm_b32 v150, v100, v96, s65
    v_perm_b32 v151, v108, v104, s65
    v_perm_b32 v154, v101, v97, s64
    v_perm_b32 v155, v109, v105, s64
    v_perm_b32 v158, v101, v97, s65
    v_perm_b32 v159, v109, v105, s65
    v_perm_b32 v162, v102, v98, s64
    v_perm_b32 v163, v110, v106, s64
    v_perm_b32 v166, v102, v98, s65
    v_perm_b32 v167, v110, v106, s65
    v_perm_b32 v170, v103, v99, s64
    v_perm_b32 v171, v111, v107, s64
    v_perm_b32 v174, v103, v99, s65
    v_perm_b32 v175, v111, v107, s65
    s_waitcnt lgkmcnt(0)
    v_cmp_eq_u32 vcc, 0, v248
    s_cmp_eq_u64 vcc, -1
    s_cbranch_scc1 L_ogo
    s_mov_b32 s15, 16000000
L_poll110:
    ds_read_b32 v248, v14 offset:3508
    s_waitcnt lgkmcnt(0)
    v_cmp_eq_u32 vcc, 0, v248
    s_cmp_eq_u64 vcc, -1
    s_cbranch_scc1 L_pdone111
    s_sub_u32 s15, s15, 1
    s_cbranch_scc1 L_pdone111
    s_sleep 1
    s_branch L_poll110
L_pdone111:
    ds_read_b128 v[244:247], v12 offset:3840
    s_waitcnt lgkmcnt(0)
L_ogo:
    ds_read_b32 v248, v14 offset:3504
    ds_read_b128 v[240:243], v12 offset:4352
    v_mfma_f32_16x16x32_bf16 v[176:179], v[244:247], v[112:115], 0
    v_mfma_f32_16x16x32_bf16 v[180:183], v[244:247], v[116:119], 0
    v_mfma_f32_16x16x32_bf16 v[184:187], v[244:247], v[120:123], 0
    v_mfma_f32_16x16x32_bf16 v[188:191], v[244:247], v[124:127], 0
    v_mfma_f32_16x16x32_bf16 v[192:195], v[244:247], v[128:131], 0
    v_mfma_f32_16x16x32_bf16 v[196:199], v[244:247], v[132:135], 0
    v_mfma_f32_16x16x32_bf16 v[200:203], v[244:247], v[136:139], 0
    v_mfma_f32_16x16x32_bf16 v[204:207], v[244:247], v[140:143], 0
    s_waitcnt lgkmcnt(0)
    v_cmp_eq_u32 vcc, 0, v248
    s_cmp_eq_u64 vcc, -1
    s_cbranch_scc1 L_hgo
    s_mov_b32 s15, 16000000
L_poll112:
    ds_read_b32 v248, v14 offset:3504
    s_waitcnt lgkmcnt(0)
    v_cmp_eq_u32 vcc, 0, v248
    s_cmp_eq_u64 vcc, -1
    s_cbranch_scc1 L_pdone113
    s_sub_u32 s15, s15, 1
    s_cbranch_scc1 L_pdone113
    s_sleep 1
    s_branch L_poll112
L_pdone113:
    ds_read_b128 v[240:243], v12 offset:4352
    s_waitcnt lgkmcnt(0)
L_hgo:
    v_mfma_f32_16x16x32_bf16 v[176:179], v[240:243], v[144:147], v[176:179]
    v_mfma_f32_16x16x32_bf16 v[180:183], v[240:243], v[148:151], v[180:183]
    v_mfma_f32_16x16x32_bf16 v[184:187], v[240:243], v[152:155], v[184:187]
    v_mfma_f32_16x16x32_bf16 v[188:191], v[240:243], v[156:159], v[188:191]
    v_mfma_f32_16x16x32_bf16 v[192:195], v[240:243], v[160:163], v[192:195]
    v_mfma_f32_16x16x32_bf16 v[196:199], v[240:243], v[164:167], v[196:199]
    v_mfma_f32_16x16x32_bf16 v[200:203], v[240:243], v[168:171], v[200:203]
    v_mfma_f32_16x16x32_bf16 v[204:207], v[240:243], v[172:175], v[204:207]
    s_nop 1
    v_add_f32_dpp v248, v177, v176 row_ror:8 row_mask:0xf bank_mask:0x3
    v_add_f32_dpp v249, v181, v180 row_ror:8 row_mask:0xf bank_mask:0x3
    v_add_f32_dpp v250, v185, v184 row_ror:8 row_mask:0xf bank_mask:0x3
    v_add_f32_dpp v251, v189, v188 row_ror:8 row_mask:0xf bank_mask:0x3
    v_add_f32_dpp v248, v192, v193 row_ror:8 row_mask:0xf bank_mask:0xc
    v_add_f32_dpp v249, v196, v197 row_ror:8 row_mask:0xf bank_mask:0xc
    s_nop 0
    v_add_f32_dpp v250, v200, v201 row_ror:8 row_mask:0xf bank_mask:0xc
    s_nop 0
    v_add_f32_dpp v251, v204, v205 row_ror:8 row_mask:0xf bank_mask:0xc
    v_bfi_b32 v248, s69, v15, v248
    v_bfi_b32 v249, s69, v15, v249
    v_bfi_b32 v250, s69, v15, v250
    v_bfi_b32 v251, s69, v15, v251
    s_mov_b32 exec_hi, 0
    s_cmp_eq_u32 s101, 1
    s_cbranch_scc1 L_stf114
    buffer_store_dwordx4 v[248:251], v11, s[48:51], s9 offen sc1
    s_branch L_std115
L_stf114:
    buffer_store_dwordx4 v[248:251], v11, s[48:51], s9 offen
L_std115:
    ds_write_b32 v13, v14 offset:3568
L_END:
    s_endpgm
.fill (24576 - (. - parallel_sum__gqa_block_cached__geglu_ffn__decode_kernel)) / 4, 4, 0xBF800000
.section .rodata,"a"
.p2align 6
.amdhsa_kernel parallel_sum__gqa_block_cached__geglu_ffn__decode_kernel
  .amdhsa_next_free_vgpr 256
  .amdhsa_next_free_sgpr 102
  .amdhsa_accum_offset 256
  .amdhsa_group_segment_fixed_size 0
  .amdhsa_kernarg_size 96
  .amdhsa_user_sgpr_count 2
  .amdhsa_user_sgpr_kernarg_segment_ptr 1
  .amdhsa_system_sgpr_workgroup_id_x 1
  .amdhsa_float_denorm_mode_32 3
.end_amdhsa_kernel
```
